```python
import torch

def _softmax(x, axis=-1):
    return torch.softmax(x, dim=axis)
def _gelu(x):
    return torch.nn.functional.gelu(x, approximate="tanh")
def _silu(x):
    return torch.nn.functional.silu(x)
def _sigmoid(x):
    return torch.sigmoid(x)
def _layernorm(x, axis=-1, eps=1e-5):
    m = x.mean(dim=axis, keepdim=True)
    v = x.var(dim=axis, keepdim=True, unbiased=False)
    return (x - m) / torch.sqrt(v + eps)
def _scatter_add(tgt, idx, src, axis=0):
    return tgt.clone().index_add_(axis, idx, src)
def _segment_sum(src, seg, n):
    out = torch.zeros((n,) + src.shape[1:], dtype=src.dtype)
    return out.index_add_(0, seg, src)
def _pad(x, pw):
    flat = tuple(v for pair in reversed(pw) for v in pair)
    return torch.nn.functional.pad(x, flat)

kernel_name = 'recurrent_scan__linear_attn_block__glu_gated_geglu__prompt'

def setup_inputs():

    _w = (lambda a: (lambda t: t.to(torch.bfloat16) if t.is_floating_point() else t)(torch.as_tensor(a)))
    def _A_setup():
        B, S, D = 1, 2048, 512
        return {
            "x": _w((lambda *s: torch.randn(*s, dtype=torch.bfloat16) * 0.05)(B, S, D)),
            "wqkv": _w((lambda *s: torch.randn(*s, dtype=torch.bfloat16) * 0.8)(D, 3 * D)),
            "wo": _w((lambda *s: torch.randn(*s, dtype=torch.bfloat16) * 0.8)(D, D)),
        }
    _A_in = _A_setup()

    def _B_setup():
        B, S, Dm, Df = 1, 2048, 512, 1792
        return {
            "x": _w((lambda *s: torch.randn(*s, dtype=torch.bfloat16) * 0.05)(B, S, Dm)),
            "w_gate": _w((lambda *s: torch.randn(*s, dtype=torch.bfloat16) * 0.2)(Dm, Df) * (Dm ** -0.5)),
            "w_up": _w((lambda *s: torch.randn(*s, dtype=torch.bfloat16) * 0.2)(Dm, Df) * (Dm ** -0.5)),
            "w_down": _w((lambda *s: torch.randn(*s, dtype=torch.bfloat16) * 0.2)(Df, Dm) * (Df ** -0.5)),
        }
    _B_in = _B_setup()

    return {
        "A_x": _A_in["x"],
        "A_wqkv": _A_in["wqkv"],
        "A_wo": _A_in["wo"],
        "B_x": _B_in["x"],
        "B_w_gate": _B_in["w_gate"],
        "B_w_up": _B_in["w_up"],
        "B_w_down": _B_in["w_down"],
    }

def reference(A_x, A_wqkv, A_wo, B_x, B_w_gate, B_w_up, B_w_down):
    def _A_ref(x, wqkv, wo):
        B, S, D = x.shape
        H = 32; Dh = D // H
        qkv = (lambda x, *d: x.permute(*d))((x @ wqkv).reshape(B, S, 3, H, Dh), 2, 0, 3, 1, 4)
        q, k, v = qkv[0], qkv[1], qkv[2]
        phi = lambda t: torch.where(t > 0, t + 1, torch.exp(t)) + 1e-6
        pq, pk = phi(q), phi(k)
        kv = torch.einsum("bhsd,bhse->bhde", pk, v)
        z = torch.einsum("bhsd->bhd", pk)
        num = torch.einsum("bhqd,bhde->bhqe", pq, kv)
        den = torch.einsum("bhqd,bhd->bhq", pq, z)[..., None] + 1e-6
        o = num / den
        return (lambda x, *d: x.permute(*d))(o, 0, 2, 1, 3).reshape(B, S, D) @ wo

    def _B_ref(x, w_gate, w_up, w_down):
        g = torch.einsum("bsd,df->bsf", x, w_gate)
        u = torch.einsum("bsd,df->bsf", x, w_up)
        h = _gelu(g) * u
        return torch.einsum("bsf,fd->bsd", h, w_down)

    x = A_x
    xn = _layernorm(x, axis=-1)
    s = _A_ref(xn, A_wqkv, A_wo)
    g = _silu(_B_ref(xn, B_w_gate, B_w_up, B_w_down))
    return x + s * g
```

```asm
; @launch grid=(256,1,1) block=(512,1,1) lds=163840
.amdgcn_target "amdgcn-amd-amdhsa--gfx950"
.text
.globl recurrent_scan__linear_attn_block__glu_gated_geglu__prompt_kernel
.p2align 8
.type recurrent_scan__linear_attn_block__glu_gated_geglu__prompt_kernel,@function
recurrent_scan__linear_attn_block__glu_gated_geglu__prompt_kernel:
    s_cmp_ge_u32 s2, 256
    s_cbranch_scc1 L_end
    s_load_dwordx4 s[4:7], s[0:1], 0
    s_load_dwordx4 s[52:55], s[0:1], 32
    s_load_dwordx4 s[56:59], s[0:1], 64
    s_load_dwordx4 s[8:11], s[0:1], 48
    s_load_dwordx2 s[12:13], s[0:1], 16
    v_mov_b32 v255, v0
    v_lshrrev_b32 v232, 6, v0
    v_and_b32 v244, 63, v0
    v_readfirstlane_b32 s60, v232
    s_and_b32 s66, s2, 7
    s_lshr_b32 s67, s2, 3
    s_lshr_b32 s68, s67, 3
    s_and_b32 s63, s66, 1
    s_lshl_b32 s63, s63, 3
    s_and_b32 s64, s67, 7
    s_add_u32 s63, s63, s64
    s_lshr_b32 s64, s66, 1
    s_lshl_b32 s64, s64, 2
    s_add_u32 s64, s64, s68
    s_lshr_b32 s65, s64, 1
    s_and_b32 s75, s67, 7
    s_lshl_b32 s74, s66, 2
    s_add_u32 s74, s74, s68
    s_and_b32 s61, s60, 3
    s_lshr_b32 s62, s60, 2
    s_lshr_b32 s48, s60, 1
    s_and_b32 s49, s60, 1
    v_lshlrev_b32 v254, 4, v244
    s_mov_b32 s70, 0x3fb8aa3b
    s_mov_b32 s71, 0x358637bd
    s_mov_b32 s72, 0xc0135761
    v_lshrrev_b32 v245, 4, v244
    v_and_b32 v246, 15, v244
    v_xor_b32 v246, v246, v245
    v_lshlrev_b32 v240, 10, v245
    v_lshl_add_u32 v240, v246, 4, v240
    v_xor_b32 v241, 64, v240
    v_xor_b32 v242, 128, v240
    v_xor_b32 v243, 192, v240
    s_and_b32 s66, s64, 1
    s_cmp_eq_u32 s66, 1
    s_cbranch_scc1 L_typeA
    s_lshl_b32 s3, s65, 7
    s_add_u32 s66, s60, 1
    s_min_u32 s66, s66, 2
    s_lshl_b32 s66, s66, 10
    s_add_u32 s3, s3, s66
    s_lshr_b32 s66, s65, 1
    s_lshl_b32 s66, s66, 7
    s_and_b32 s67, s65, 1
    s_lshl_b32 s67, s67, 6
    s_add_u32 s66, s66, s67
    s_add_u32 s66, s66, 3072
    s_cmp_ge_u32 s60, 4
    s_cselect_b32 s3, s66, s3
    s_sub_u32 s79, s60, 1
    s_sub_u32 s66, s60, 3
    s_sub_u32 s79, s60, 1
    s_sub_u32 s66, s60, 3
    s_cmp_ge_u32 s60, 4
    s_cselect_b32 s79, s66, s79
    s_cmp_lt_u32 s60, 2
    s_cselect_b32 s79, 0, s79
    s_cmp_eq_u32 s79, 0
    s_mov_b32 s66, 3072
    s_mov_b32 s67, 3584
    s_cmp_eq_u32 s79, 0
    s_cselect_b32 s68, s66, s67
    s_cmp_ge_u32 s60, 4
    s_cselect_b32 s66, 2, 3
    s_cselect_b32 s67, 3, 7
    v_lshrrev_b32 v245, s66, v244
    v_and_b32 v246, s67, v244
    v_mul_lo_u32 v245, v245, s68
    v_lshl_add_u32 v245, v246, 4, v245
    s_cmp_ge_u32 s60, 6
    s_cselect_b32 s66, 0x7ff00000, 0
    v_add_u32 v245, s66, v245
    s_lshl_b32 s66, s63, 5
    s_mul_i32 s66, s66, s68
    s_add_u32 s3, s3, s66
    s_mul_i32 s30, s68, 512
    s_mov_b32 s31, 0x20000
    s_cmp_ge_u32 s60, 4
    s_cselect_b32 s66, 4, 3
    s_lshl_b32 s68, s68, s66
    s_waitcnt lgkmcnt(0)
    s_lshl_b32 s66, s63, 17
    s_add_u32 s16, s4, s66
    s_addc_u32 s17, s5, 0
    s_mov_b32 s18, 131072
    s_mov_b32 s19, 0x20000
    s_lshl_b32 s66, s64, 3
    s_add_u32 s66, s66, s60
    s_lshl_b32 s66, s66, 10
    buffer_load_dwordx4 v[128:131], v254, s[16:19], s66 offen
    s_cmp_eq_u32 s79, 1
    s_cselect_b32 s28, s52, s6
    s_cselect_b32 s29, s53, s7
    s_cmp_eq_u32 s79, 2
    s_cselect_b32 s28, s54, s28
    s_cselect_b32 s29, s55, s29
    buffer_load_dwordx4 v[160:163], v245, s[28:31], s3 offen
    s_add_u32 s3, s3, s68
    buffer_load_dwordx4 v[164:167], v245, s[28:31], s3 offen
    s_add_u32 s3, s3, s68
    s_and_b32 s66, s60, 6
    s_cmp_eq_u32 s66, 4
    s_cselect_b32 s66, 0x7ff00000, 0
    v_add_u32 v245, s66, v245
    buffer_load_dwordx4 v[168:171], v245, s[28:31], s3 offen
    s_add_u32 s3, s3, s68
    buffer_load_dwordx4 v[172:175], v245, s[28:31], s3 offen
    s_mov_b32 s66, 10616832
    s_add_u32 s36, s58, s66
    s_addc_u32 s37, s59, 0
    s_mov_b32 s38, 458752
    s_mov_b32 s39, 0x20000
    v_lshlrev_b32 v180, 4, v255
    v_mov_b32 v176, 0
    v_mov_b32 v177, 0
    v_mov_b32 v178, 0
    v_mov_b32 v179, 0
    s_cmp_eq_u32 s2, 0
    s_cselect_b32 s66, 0, 0x7ff00000
    v_add_u32 v180, s66, v180
    buffer_store_dwordx4 v[176:179], v180, s[36:39], 0 offen sc1
    s_mov_b32 s66, 8192
    buffer_store_dwordx4 v[176:179], v180, s[36:39], s66 offen sc1
    s_lshl_b32 s66, s60, 14
    s_add_u32 s66, s66, 0
    s_lshl_b32 m0, s60, 12
    s_add_u32 m0, m0, 0
    s_nop 0
    buffer_load_dwordx4 v240, s[16:19], s66 offen lds
    s_lshl_b32 s66, s60, 14
    s_add_u32 s66, s66, 4096
    s_lshl_b32 m0, s60, 12
    s_add_u32 m0, m0, 1024
    s_nop 0
    buffer_load_dwordx4 v241, s[16:19], s66 offen lds
    s_lshl_b32 s66, s60, 14
    s_add_u32 s66, s66, 8192
    s_lshl_b32 m0, s60, 12
    s_add_u32 m0, m0, 2048
    s_nop 0
    buffer_load_dwordx4 v242, s[16:19], s66 offen lds
    s_lshl_b32 s66, s60, 14
    s_add_u32 s66, s66, 12288
    s_lshl_b32 m0, s60, 12
    s_add_u32 m0, m0, 3072
    s_nop 0
    buffer_load_dwordx4 v243, s[16:19], s66 offen lds
    v_and_b32 v247, 63, v255
    v_lshrrev_b32 v248, 3, v247
    v_mul_u32_u24 v218, 3072, v248
    v_and_b32 v248, 7, v247
    v_bfe_u32 v249, v247, 4, 1
    v_lshlrev_b32 v249, 2, v249
    v_xor_b32 v248, v248, v249
    v_lshl_add_u32 v218, v248, 4, v218
    v_mov_b32 v219, v218
    s_mov_b32 s20, s6
    s_mov_b32 s21, s7
    s_mov_b32 s22, 1572864
    s_mov_b32 s23, 0x20000
    s_mov_b32 s24, s6
    s_mov_b32 s25, s7
    s_mov_b32 s26, 1572864
    s_mov_b32 s27, 0x20000
    s_lshl_b32 s14, s65, 7
    s_mul_i32 s66, s60, 24576
    s_add_u32 s14, s14, s66
    s_add_u32 s15, s14, 2048
    s_add_u32 s14, s14, 1024
    s_lshl_b32 s69, s60, 10
    s_add_u32 s66, s14, 0
    s_add_u32 m0, s69, 131072
    s_nop 0
    buffer_load_dwordx4 v218, s[20:23], s66 offen lds
    s_add_u32 s66, s15, 0
    s_add_u32 m0, s69, 139264
    s_nop 0
    buffer_load_dwordx4 v219, s[24:27], s66 offen lds
    s_add_u32 s66, s14, 196608
    s_add_u32 m0, s69, 114688
    s_nop 0
    buffer_load_dwordx4 v218, s[20:23], s66 offen lds
    s_add_u32 s66, s15, 196608
    s_add_u32 m0, s69, 122880
    s_nop 0
    buffer_load_dwordx4 v219, s[24:27], s66 offen lds
    s_barrier
    s_lshl_b32 s66, s60, 14
    s_add_u32 s66, s66, 256
    s_lshl_b32 m0, s60, 12
    s_add_u32 m0, m0, 32768
    s_nop 0
    buffer_load_dwordx4 v240, s[16:19], s66 offen lds
    s_lshl_b32 s66, s60, 14
    s_add_u32 s66, s66, 4352
    s_lshl_b32 m0, s60, 12
    s_add_u32 m0, m0, 33792
    s_nop 0
    buffer_load_dwordx4 v241, s[16:19], s66 offen lds
    s_lshl_b32 s66, s60, 14
    s_add_u32 s66, s66, 8448
    s_lshl_b32 m0, s60, 12
    s_add_u32 m0, m0, 34816
    s_nop 0
    buffer_load_dwordx4 v242, s[16:19], s66 offen lds
    s_lshl_b32 s66, s60, 14
    s_add_u32 s66, s66, 12544
    s_lshl_b32 m0, s60, 12
    s_add_u32 m0, m0, 35840
    s_nop 0
    buffer_load_dwordx4 v243, s[16:19], s66 offen lds
    s_mul_i32 s66, s65, 69632
    s_add_u32 s66, s66, 11010048
    s_add_u32 s32, s58, s66
    s_addc_u32 s33, s59, 0
    s_mov_b32 s34, 69632
    s_mov_b32 s35, 0x20000
    s_lshl_b32 s66, s63, 2
    s_add_u32 s66, s66, s61
    s_mul_i32 s66, s66, 147456
    s_add_u32 s28, s58, s66
    s_addc_u32 s29, s59, 0
    s_mov_b32 s30, 147456
    s_mov_b32 s31, 0x20000
    v_mov_b32 v226, 0
    v_mov_b32 v227, 0
    v_mov_b32 v230, 0
    v_mov_b32 v231, 0
    v_and_b32 v245, 31, v255
    v_bfe_u32 v246, v255, 5, 1
    v_and_b32 v232, 15, v245
    v_xor_b32 v246, v232, v246
    s_lshl_b32 s66, s61, 5
    v_add_u32 v245, s66, v245
    v_lshlrev_b32 v232, 8, v245
    v_lshl_add_u32 v232, v246, 4, v232
    v_xor_b32 v233, 32, v232
    v_xor_b32 v234, 64, v232
    v_xor_b32 v235, 96, v232
    v_xor_b32 v236, 128, v232
    v_xor_b32 v237, 160, v232
    v_xor_b32 v238, 192, v232
    v_xor_b32 v239, 224, v232
    v_and_b32 v247, 63, v255
    v_lshrrev_b32 v248, 5, v247
    v_lshlrev_b32 v248, 3, v248
    v_bfe_u32 v249, v247, 2, 2
    v_add_u32 v248, v248, v249
    v_lshlrev_b32 v216, 7, v248
    v_bfe_u32 v248, v247, 1, 1
    v_bfe_u32 v249, v247, 4, 1
    s_lshl_b32 s66, s62, 2
    v_add_u32 v248, s66, v248
    v_lshl_add_u32 v248, v249, 1, v248
    v_bfe_u32 v249, v247, 3, 1
    v_lshlrev_b32 v249, 2, v249
    v_xor_b32 v248, v248, v249
    v_lshl_add_u32 v216, v248, 4, v216
    v_and_b32 v248, 1, v247
    v_lshl_add_u32 v216, v248, 3, v216
    v_add_u32 v216, 0x20000, v216
    v_add_u32 v217, 0x2000, v216
    s_waitcnt vmcnt(18)
    v_lshlrev_b32 v136, 16, v128
    v_and_b32 v137, 0xffff0000, v128
    v_lshlrev_b32 v138, 16, v129
    v_and_b32 v139, 0xffff0000, v129
    v_lshlrev_b32 v140, 16, v130
    v_and_b32 v141, 0xffff0000, v130
    v_lshlrev_b32 v142, 16, v131
    v_and_b32 v143, 0xffff0000, v131
    v_add_f32 v144, v136, v137
    v_mul_f32 v145, v136, v136
    v_add_f32 v144, v144, v138
    v_add_f32 v144, v144, v139
    v_add_f32 v144, v144, v140
    v_add_f32 v144, v144, v141
    v_add_f32 v144, v144, v142
    v_add_f32 v144, v144, v143
    v_fma_f32 v145, v137, v137, v145
    v_fma_f32 v145, v138, v138, v145
    v_fma_f32 v145, v139, v139, v145
    v_fma_f32 v145, v140, v140, v145
    v_fma_f32 v145, v141, v141, v145
    v_fma_f32 v145, v142, v142, v145
    v_fma_f32 v145, v143, v143, v145
    v_mov_b32_dpp v136, v144 row_shr:1 row_mask:0xf bank_mask:0xf bound_ctrl:1
    s_nop 0
    v_mov_b32_dpp v137, v145 row_shr:1 row_mask:0xf bank_mask:0xf bound_ctrl:1
    v_add_f32 v144, v144, v136
    v_add_f32 v145, v145, v137
    s_nop 0
    v_mov_b32_dpp v136, v144 row_shr:2 row_mask:0xf bank_mask:0xf bound_ctrl:1
    v_mov_b32_dpp v137, v145 row_shr:2 row_mask:0xf bank_mask:0xf bound_ctrl:1
    v_add_f32 v144, v144, v136
    v_add_f32 v145, v145, v137
    s_nop 0
    v_mov_b32_dpp v136, v144 row_shr:4 row_mask:0xf bank_mask:0xf bound_ctrl:1
    v_mov_b32_dpp v137, v145 row_shr:4 row_mask:0xf bank_mask:0xf bound_ctrl:1
    v_add_f32 v144, v144, v136
    v_add_f32 v145, v145, v137
    s_nop 0
    v_mov_b32_dpp v136, v144 row_shr:8 row_mask:0xf bank_mask:0xf bound_ctrl:1
    v_mov_b32_dpp v137, v145 row_shr:8 row_mask:0xf bank_mask:0xf bound_ctrl:1
    v_add_f32 v144, v144, v136
    v_add_f32 v145, v145, v137
    v_mov_b32 v136, 0
    v_mov_b32 v137, 0
    s_nop 0
    v_mov_b32_dpp v136, v144 row_bcast:15 row_mask:0xa bank_mask:0xf
    v_mov_b32_dpp v137, v145 row_bcast:15 row_mask:0xa bank_mask:0xf
    v_add_f32 v144, v144, v136
    v_add_f32 v145, v145, v137
    v_mov_b32 v136, 0
    v_mov_b32 v137, 0
    s_nop 0
    v_mov_b32_dpp v136, v144 row_bcast:31 row_mask:0xc bank_mask:0xf
    v_mov_b32_dpp v137, v145 row_bcast:31 row_mask:0xc bank_mask:0xf
    v_add_f32 v144, v144, v136
    v_add_f32 v145, v145, v137
    v_mul_f32 v144, 0x3b000000, v144
    v_mul_f32 v145, 0x3b000000, v145
    v_fma_f32 v145, -v144, v144, v145
    v_add_f32 v145, 0x3727c5ac, v145
    v_rsq_f32 v139, v145
    v_sub_f32 v138, 0, v144
    v_and_b32 v140, 63, v255
    s_lshl_b32 s68, s63, 7
    s_lshl_b32 s67, s64, 3
    s_add_u32 s68, s68, s67
    s_add_u32 s68, s68, s60
    s_lshl_b32 s68, s68, 3
    s_add_u32 s68, s68, 65536
    v_mov_b32 v141, s68
    v_mov_b32 v142, 0x7ff00000
    v_cmp_eq_u32 vcc, 63, v140
    s_nop 1
    v_cndmask_b32 v141, v142, v141, vcc
    buffer_store_dwordx2 v[138:139], v141, s[36:39], 0 offen sc1
    s_waitcnt vmcnt(18)
    v_lshlrev_b32 v144, 16, v160
    v_and_b32 v145, 0xffff0000, v160
    v_lshlrev_b32 v146, 16, v161
    v_and_b32 v147, 0xffff0000, v161
    v_lshlrev_b32 v148, 16, v162
    v_and_b32 v149, 0xffff0000, v162
    v_lshlrev_b32 v150, 16, v163
    v_and_b32 v151, 0xffff0000, v163
    s_waitcnt vmcnt(17)
    v_lshlrev_b32 v152, 16, v164
    v_and_b32 v153, 0xffff0000, v164
    v_lshlrev_b32 v154, 16, v165
    v_and_b32 v155, 0xffff0000, v165
    v_lshlrev_b32 v156, 16, v166
    v_and_b32 v157, 0xffff0000, v166
    v_lshlrev_b32 v158, 16, v167
    v_and_b32 v159, 0xffff0000, v167
    v_add_f32 v144, v144, v152
    v_add_f32 v145, v145, v153
    v_add_f32 v146, v146, v154
    v_add_f32 v147, v147, v155
    v_add_f32 v148, v148, v156
    v_add_f32 v149, v149, v157
    v_add_f32 v150, v150, v158
    v_add_f32 v151, v151, v159
    s_waitcnt vmcnt(16)
    v_lshlrev_b32 v152, 16, v168
    v_and_b32 v153, 0xffff0000, v168
    v_lshlrev_b32 v154, 16, v169
    v_and_b32 v155, 0xffff0000, v169
    v_lshlrev_b32 v156, 16, v170
    v_and_b32 v157, 0xffff0000, v170
    v_lshlrev_b32 v158, 16, v171
    v_and_b32 v159, 0xffff0000, v171
    v_add_f32 v144, v144, v152
    v_add_f32 v145, v145, v153
    v_add_f32 v146, v146, v154
    v_add_f32 v147, v147, v155
    v_add_f32 v148, v148, v156
    v_add_f32 v149, v149, v157
    v_add_f32 v150, v150, v158
    v_add_f32 v151, v151, v159
    s_waitcnt vmcnt(15)
    v_lshlrev_b32 v152, 16, v172
    v_and_b32 v153, 0xffff0000, v172
    v_lshlrev_b32 v154, 16, v173
    v_and_b32 v155, 0xffff0000, v173
    v_lshlrev_b32 v156, 16, v174
    v_and_b32 v157, 0xffff0000, v174
    v_lshlrev_b32 v158, 16, v175
    v_and_b32 v159, 0xffff0000, v175
    v_add_f32 v144, v144, v152
    v_add_f32 v145, v145, v153
    v_add_f32 v146, v146, v154
    v_add_f32 v147, v147, v155
    v_add_f32 v148, v148, v156
    v_add_f32 v149, v149, v157
    v_add_f32 v150, v150, v158
    v_add_f32 v151, v151, v159
    v_and_b32 v136, 63, v255
    v_bfe_u32 v137, v136, 2, 3
    v_lshlrev_b32 v137, 3, v137
    v_bfe_u32 v138, v136, 5, 1
    v_lshl_add_u32 v137, v138, 2, v137
    v_and_b32 v138, 3, v136
    v_add_u32 v137, v137, v138
    s_and_b32 s68, s60, 6
    s_cmp_eq_u32 s68, 4
    s_cselect_b32 s68, 1, 0
    v_mov_b32 v138, s68
    v_cmp_eq_u32 vcc, 1, v138
    s_nop 1
    v_cndmask_b32 v136, v136, v137, vcc
    v_lshlrev_b32 v136, 5, v136
    s_lshl_b32 s68, s60, 11
    s_add_u32 s68, s68, 147456
    v_add_u32 v136, s68, v136
    ds_write_b128 v136, v[144:147]
    ds_write_b128 v136, v[148:151] offset:16
    s_waitcnt vmcnt(7)
    s_waitcnt lgkmcnt(0)
    s_barrier
    s_cmp_lg_u32 s2, 0
    s_cbranch_scc1 L_zfa1
    v_mov_b32 v250, 0
    v_mov_b32 v251, 1
    global_store_dword v250, v251, s[56:57] sc1
    s_nop 1
L_zfa1:
    ds_read_b128 v[0:3], v232 offset:0
    ds_read_b128 v[4:7], v233 offset:0
    ds_read_b128 v[8:11], v234 offset:0
    ds_read_b128 v[12:15], v235 offset:0
    ds_read_b128 v[16:19], v236 offset:0
    ds_read_b128 v[20:23], v237 offset:0
    ds_read_b128 v[24:27], v238 offset:0
    ds_read_b128 v[28:31], v239 offset:0
    ds_read_b64_tr_b16 v[192:193], v216 offset:0
    ds_read_b64_tr_b16 v[194:195], v216 offset:512
    ds_read_b64_tr_b16 v[196:197], v217 offset:0
    ds_read_b64_tr_b16 v[198:199], v217 offset:512
    ds_read_b64_tr_b16 v[200:201], v216 offset:2048
    ds_read_b64_tr_b16 v[202:203], v216 offset:2560
    ds_read_b64_tr_b16 v[204:205], v217 offset:2048
    ds_read_b64_tr_b16 v[206:207], v217 offset:2560
    s_waitcnt vmcnt(5)
    s_waitcnt lgkmcnt(0)
    s_barrier
    v_mfma_f32_32x32x16_bf16 v[128:143], v[0:3], v[192:195], 0
    ds_read_b64_tr_b16 v[208:209], v216 offset:4096
    ds_read_b64_tr_b16 v[210:211], v216 offset:4608
    s_add_u32 s66, s14, 393216
    s_add_u32 m0, s69, 98304
    s_nop 0
    buffer_load_dwordx4 v218, s[20:23], s66 offen lds
    s_add_u32 s66, s15, 393216
    s_add_u32 m0, s69, 106496
    s_nop 0
    buffer_load_dwordx4 v219, s[24:27], s66 offen lds
    v_and_b32 v177, 63, v255
    v_and_b32 v178, 7, v177
    v_lshlrev_b32 v178, 2, v178
    v_lshrrev_b32 v179, 3, v177
    v_lshl_add_u32 v182, v179, 5, v178
    s_lshl_b32 s68, s60, 11
    s_add_u32 s68, s68, 147456
    v_add_u32 v180, s68, v182
    v_mfma_f32_32x32x16_bf16 v[144:159], v[0:3], v[196:199], 0
    ds_read_b64_tr_b16 v[212:213], v217 offset:4096
    ds_read_b64_tr_b16 v[214:215], v217 offset:4608
    s_add_u32 s66, s14, 589824
    s_add_u32 m0, s69, 81920
    s_nop 0
    buffer_load_dwordx4 v218, s[20:23], s66 offen lds
    s_add_u32 s66, s15, 589824
    s_add_u32 m0, s69, 90112
    s_nop 0
    buffer_load_dwordx4 v219, s[24:27], s66 offen lds
    v_add_u32 v181, 0x27000, v182
    v_and_b32 v182, 3, v179
    v_lshl_add_u32 v182, v182, 5, v178
    v_lshrrev_b32 v179, 2, v179
    v_lshl_add_u32 v182, v179, 11, v182
    v_add_u32 v182, 0x26000, v182
    v_add_u32 v183, 128, v182
    v_mfma_f32_32x32x16_bf16 v[128:143], v[4:7], v[200:203], v[128:143]
    ds_read_b64_tr_b16 v[192:193], v216 offset:6144
    ds_read_b64_tr_b16 v[194:195], v216 offset:6656
    s_lshl_b32 s66, s60, 14
    s_add_u32 s66, s66, 512
    s_lshl_b32 m0, s60, 12
    s_add_u32 m0, m0, 0
    s_nop 0
    buffer_load_dwordx4 v240, s[16:19], s66 offen lds
    v_mov_b32 v179, s60
    v_cmp_eq_u32 vcc, 4, v179
    s_nop 1
    v_cndmask_b32 v180, v180, v182, vcc
    v_cndmask_b32 v181, v181, v183, vcc
    ds_read_b32 v160, v180 offset:0
    ds_read_b32 v161, v180 offset:256
    ds_read_b32 v162, v180 offset:512
    ds_read_b32 v163, v180 offset:768
    v_mfma_f32_32x32x16_bf16 v[144:159], v[4:7], v[204:207], v[144:159]
    ds_read_b64_tr_b16 v[196:197], v217 offset:6144
    ds_read_b64_tr_b16 v[198:199], v217 offset:6656
    s_lshl_b32 s66, s60, 14
    s_add_u32 s66, s66, 4608
    s_lshl_b32 m0, s60, 12
    s_add_u32 m0, m0, 1024
    s_nop 0
    buffer_load_dwordx4 v241, s[16:19], s66 offen lds
    ds_read_b32 v164, v180 offset:1024
    ds_read_b32 v165, v180 offset:1280
    ds_read_b32 v166, v180 offset:1536
    ds_read_b32 v167, v180 offset:1792
    ds_read_b32 v168, v181 offset:0
    ds_read_b32 v169, v181 offset:256
    ds_read_b32 v170, v181 offset:512
    s_waitcnt lgkmcnt(15)
    v_mfma_f32_32x32x16_bf16 v[128:143], v[8:11], v[208:211], v[128:143]
    v_add_u32 v216, 0xffff0000, v216
    v_add_u32 v217, 0xffff0000, v217
    ds_read_b64_tr_b16 v[200:201], v216 offset:49152
    ds_read_b64_tr_b16 v[202:203], v216 offset:49664
    s_lshl_b32 s66, s60, 14
    s_add_u32 s66, s66, 8704
    s_lshl_b32 m0, s60, 12
    s_add_u32 m0, m0, 2048
    s_nop 0
    buffer_load_dwordx4 v242, s[16:19], s66 offen lds
    ds_read_b32 v171, v181 offset:768
    ds_read_b32 v172, v181 offset:1024
    ds_read_b32 v173, v181 offset:1280
    ds_read_b32 v174, v181 offset:1536
    ds_read_b32 v175, v181 offset:1792
    v_lshlrev_b32 v176, 2, v255
    v_mfma_f32_32x32x16_bf16 v[144:159], v[8:11], v[212:215], v[144:159]
    ds_read_b64_tr_b16 v[204:205], v217 offset:49152
    ds_read_b64_tr_b16 v[206:207], v217 offset:49664
    s_lshl_b32 s66, s60, 14
    s_add_u32 s66, s66, 12800
    s_lshl_b32 m0, s60, 12
    s_add_u32 m0, m0, 3072
    s_nop 0
    buffer_load_dwordx4 v243, s[16:19], s66 offen lds
    v_mov_b32 v177, 0x7ff00000
    v_cmp_gt_u32 vcc, 320, v255
    s_nop 1
    v_cndmask_b32 v176, v177, v176, vcc
    s_waitcnt lgkmcnt(15)
    v_add_f32 v160, v160, v161
    v_add_f32 v162, v162, v163
    s_waitcnt lgkmcnt(14)
    v_add_f32 v164, v164, v165
    s_waitcnt lgkmcnt(12)
    v_add_f32 v166, v166, v167
    v_mfma_f32_32x32x16_bf16 v[128:143], v[12:15], v[192:195], v[128:143]
    ds_read_b64_tr_b16 v[208:209], v216 offset:51200
    ds_read_b64_tr_b16 v[210:211], v216 offset:51712
    s_add_u32 s66, s14, 786432
    s_add_u32 m0, s69, 65536
    s_nop 0
    buffer_load_dwordx4 v218, s[20:23], s66 offen lds
    s_waitcnt lgkmcnt(12)
    v_add_f32 v168, v168, v169
    s_waitcnt lgkmcnt(8)
    v_add_f32 v170, v170, v171
    s_waitcnt lgkmcnt(6)
    v_add_f32 v172, v172, v173
    s_waitcnt lgkmcnt(4)
    v_add_f32 v174, v174, v175
    v_add_f32 v160, v160, v162
    v_add_f32 v164, v164, v166
    v_mfma_f32_32x32x16_bf16 v[144:159], v[12:15], v[196:199], v[144:159]
    ds_read_b64_tr_b16 v[212:213], v217 offset:51200
    ds_read_b64_tr_b16 v[214:215], v217 offset:51712
    s_add_u32 s66, s15, 786432
    s_add_u32 m0, s69, 73728
    s_nop 0
    buffer_load_dwordx4 v219, s[24:27], s66 offen lds
    v_add_f32 v168, v168, v170
    v_add_f32 v172, v172, v174
    v_add_f32 v160, v160, v164
    v_add_f32 v168, v168, v172
    v_add_f32 v160, v160, v168
    s_lshl_b32 s68, s64, 4
    s_add_u32 s68, s68, s63
    s_mul_i32 s68, s68, 1280
    s_add_u32 s68, s68, 131072
    buffer_store_dword v160, v176, s[36:39], s68 offen sc1
    s_waitcnt vmcnt(9)
    s_barrier
    v_mov_b32 v250, 0
    global_load_dword v244, v250, s[56:57] sc1
    s_waitcnt lgkmcnt(4)
    v_mfma_f32_32x32x16_bf16 v[128:143], v[16:19], v[200:203], v[128:143]
    ds_read_b64_tr_b16 v[192:193], v216 offset:53248
    ds_read_b64_tr_b16 v[194:195], v216 offset:53760
    s_add_u32 s66, s14, 983040
    s_add_u32 m0, s69, 131072
    s_nop 0
    buffer_load_dwordx4 v218, s[20:23], s66 offen lds
    ds_read_b128 v[32:35], v232 offset:32768
    v_mfma_f32_32x32x16_bf16 v[144:159], v[16:19], v[204:207], v[144:159]
    ds_read_b64_tr_b16 v[196:197], v217 offset:53248
    ds_read_b64_tr_b16 v[198:199], v217 offset:53760
    s_add_u32 s66, s15, 983040
    s_add_u32 m0, s69, 139264
    s_nop 0
    buffer_load_dwordx4 v219, s[24:27], s66 offen lds
    ds_read_b128 v[36:39], v233 offset:32768
    s_waitcnt lgkmcnt(6)
    v_mfma_f32_32x32x16_bf16 v[128:143], v[20:23], v[208:211], v[128:143]
    ds_read_b64_tr_b16 v[200:201], v216 offset:55296
    ds_read_b64_tr_b16 v[202:203], v216 offset:55808
    ds_read_b128 v[40:43], v234 offset:32768
    v_mfma_f32_32x32x16_bf16 v[144:159], v[20:23], v[212:215], v[144:159]
    ds_read_b64_tr_b16 v[204:205], v217 offset:55296
    ds_read_b64_tr_b16 v[206:207], v217 offset:55808
    ds_read_b128 v[44:47], v235 offset:32768
    s_waitcnt lgkmcnt(7)
    v_mfma_f32_32x32x16_bf16 v[128:143], v[24:27], v[192:195], v[128:143]
    ds_read_b64_tr_b16 v[208:209], v216 offset:32768
    ds_read_b64_tr_b16 v[210:211], v216 offset:33280
    ds_read_b128 v[48:51], v236 offset:32768
    v_mfma_f32_32x32x16_bf16 v[144:159], v[24:27], v[196:199], v[144:159]
    ds_read_b64_tr_b16 v[212:213], v217 offset:32768
    ds_read_b64_tr_b16 v[214:215], v217 offset:33280
    ds_read_b128 v[52:55], v237 offset:32768
    s_waitcnt lgkmcnt(7)
    v_mfma_f32_32x32x16_bf16 v[128:143], v[28:31], v[200:203], v[128:143]
    ds_read_b64_tr_b16 v[192:193], v216 offset:34816
    ds_read_b64_tr_b16 v[194:195], v216 offset:35328
    ds_read_b128 v[56:59], v238 offset:32768
    v_mfma_f32_32x32x16_bf16 v[144:159], v[28:31], v[204:207], v[144:159]
    ds_read_b64_tr_b16 v[196:197], v217 offset:34816
    ds_read_b64_tr_b16 v[198:199], v217 offset:35328
    ds_read_b128 v[60:63], v239 offset:32768
    s_waitcnt vmcnt(3)
    s_waitcnt lgkmcnt(0)
    s_barrier
    s_waitcnt vmcnt(2)
    v_readfirstlane_b32 s66, v244
    s_cmp_lg_u32 s60, 0
    s_cbranch_scc1 L_zf2
    s_nop 2
    s_cmp_lg_u32 s66, 0
    s_cbranch_scc1 L_zf2
    v_mov_b32 v250, 0
    s_mov_b32 s78, 0x40000
L_spin3:
    global_load_dword v251, v250, s[56:57] sc1
    s_waitcnt vmcnt(0)
    v_readfirstlane_b32 s66, v251
    s_nop 3
    s_cmp_lg_u32 s66, 0
    s_cbranch_scc1 L_spun3
    s_sleep 8
    s_sub_u32 s78, s78, 1
    s_cbranch_scc0 L_spin3
L_spun3:
L_zf2:
    s_cmp_lg_u32 s60, 0
    s_cbranch_scc1 L_cnt4
    s_add_u32 s66, s63, 0
    s_lshl_b32 s66, s66, 5
    s_add_u32 s66, s66, s64
    s_lshl_b32 s66, s66, 2
    v_mov_b32 v250, s66
    v_mov_b32 v251, 1
    s_mov_b64 s[76:77], exec
    s_mov_b64 exec, 1
    buffer_store_dword v251, v250, s[36:39], 0 offen sc1
    s_mov_b64 exec, s[76:77]
    s_nop 1
L_cnt4:
    s_cmp_lg_u32 s60, 0
    s_cbranch_scc1 L_cnt5
    s_add_u32 s66, s64, 16
    s_lshl_b32 s66, s66, 5
    s_add_u32 s66, s66, s63
    s_lshl_b32 s66, s66, 2
    v_mov_b32 v250, s66
    v_mov_b32 v251, 1
    s_mov_b64 s[76:77], exec
    s_mov_b64 exec, 1
    buffer_store_dword v251, v250, s[36:39], 0 offen sc1
    s_mov_b64 exec, s[76:77]
    s_nop 1
L_cnt5:
    v_mfma_f32_32x32x16_bf16 v[128:143], v[32:35], v[208:211], v[128:143]
    ds_read_b64_tr_b16 v[200:201], v216 offset:36864
    ds_read_b64_tr_b16 v[202:203], v216 offset:37376
    s_lshl_b32 s66, s60, 14
    s_add_u32 s66, s66, 768
    s_lshl_b32 m0, s60, 12
    s_add_u32 m0, m0, 32768
    s_nop 0
    buffer_load_dwordx4 v240, s[16:19], s66 offen lds
    v_mfma_f32_32x32x16_bf16 v[144:159], v[32:35], v[212:215], v[144:159]
    ds_read_b64_tr_b16 v[204:205], v217 offset:36864
    ds_read_b64_tr_b16 v[206:207], v217 offset:37376
    s_lshl_b32 s66, s60, 14
    s_add_u32 s66, s66, 4864
    s_lshl_b32 m0, s60, 12
    s_add_u32 m0, m0, 33792
    s_nop 0
    buffer_load_dwordx4 v241, s[16:19], s66 offen lds
    v_mfma_f32_32x32x16_bf16 v[128:143], v[36:39], v[192:195], v[128:143]
    ds_read_b64_tr_b16 v[208:209], v216 offset:38912
    ds_read_b64_tr_b16 v[210:211], v216 offset:39424
    s_lshl_b32 s66, s60, 14
    s_add_u32 s66, s66, 8960
    s_lshl_b32 m0, s60, 12
    s_add_u32 m0, m0, 34816
    s_nop 0
    buffer_load_dwordx4 v242, s[16:19], s66 offen lds
    v_mfma_f32_32x32x16_bf16 v[144:159], v[36:39], v[196:199], v[144:159]
    ds_read_b64_tr_b16 v[212:213], v217 offset:38912
    ds_read_b64_tr_b16 v[214:215], v217 offset:39424
    s_lshl_b32 s66, s60, 14
    s_add_u32 s66, s66, 13056
    s_lshl_b32 m0, s60, 12
    s_add_u32 m0, m0, 35840
    s_nop 0
    buffer_load_dwordx4 v243, s[16:19], s66 offen lds
    s_waitcnt lgkmcnt(4)
    v_mfma_f32_32x32x16_bf16 v[128:143], v[40:43], v[200:203], v[128:143]
    ds_read_b64_tr_b16 v[192:193], v216 offset:16384
    ds_read_b64_tr_b16 v[194:195], v216 offset:16896
    s_add_u32 s66, s14, 1179648
    s_add_u32 m0, s69, 114688
    s_nop 0
    buffer_load_dwordx4 v218, s[20:23], s66 offen lds
    v_mfma_f32_32x32x16_bf16 v[144:159], v[40:43], v[204:207], v[144:159]
    ds_read_b64_tr_b16 v[196:197], v217 offset:16384
    ds_read_b64_tr_b16 v[198:199], v217 offset:16896
    s_add_u32 s66, s15, 1179648
    s_add_u32 m0, s69, 122880
    s_nop 0
    buffer_load_dwordx4 v219, s[24:27], s66 offen lds
    s_waitcnt lgkmcnt(4)
    v_mfma_f32_32x32x16_bf16 v[128:143], v[44:47], v[208:211], v[128:143]
    ds_read_b64_tr_b16 v[200:201], v216 offset:18432
    ds_read_b64_tr_b16 v[202:203], v216 offset:18944
    v_mfma_f32_32x32x16_bf16 v[144:159], v[44:47], v[212:215], v[144:159]
    ds_read_b64_tr_b16 v[204:205], v217 offset:18432
    ds_read_b64_tr_b16 v[206:207], v217 offset:18944
    s_barrier
    s_mov_b32 s44, s8
    s_mov_b32 s45, s9
    s_mov_b32 s46, 0
    s_mov_b32 s47, 0x20000
    s_mov_b32 s68, 0
    s_cmp_eq_u32 s60, 0
    s_cselect_b32 s44, s8, s44
    s_cselect_b32 s45, s9, s45
    s_mov_b32 s66, 1835008
    s_cselect_b32 s46, s66, s46
    s_mul_i32 s66, s2, 7168
    s_cselect_b32 s68, s66, s68
    s_cmp_eq_u32 s60, 1
    s_cselect_b32 s44, s12, s44
    s_cselect_b32 s45, s13, s45
    s_mov_b32 s66, 524288
    s_cselect_b32 s46, s66, s46
    s_mul_i32 s66, s2, 2048
    s_cselect_b32 s68, s66, s68
    v_lshlrev_b32 v247, 3, v254
    buffer_load_dword v220, v247, s[44:47], s68 offen
    s_waitcnt lgkmcnt(4)
    v_mfma_f32_32x32x16_bf16 v[128:143], v[48:51], v[192:195], v[128:143]
    ds_read_b64_tr_b16 v[208:209], v216 offset:20480
    ds_read_b64_tr_b16 v[210:211], v216 offset:20992
    s_add_u32 s66, s14, 1376256
    s_add_u32 m0, s69, 98304
    s_nop 0
    buffer_load_dwordx4 v218, s[20:23], s66 offen lds
    ds_read_b128 v[64:67], v232 offset:0
    v_mfma_f32_32x32x16_bf16 v[144:159], v[48:51], v[196:199], v[144:159]
    ds_read_b64_tr_b16 v[212:213], v217 offset:20480
    ds_read_b64_tr_b16 v[214:215], v217 offset:20992
    s_add_u32 s66, s15, 1376256
    s_add_u32 m0, s69, 106496
    s_nop 0
    buffer_load_dwordx4 v219, s[24:27], s66 offen lds
    ds_read_b128 v[68:71], v233 offset:0
    s_waitcnt lgkmcnt(6)
    v_mfma_f32_32x32x16_bf16 v[128:143], v[52:55], v[200:203], v[128:143]
    ds_read_b64_tr_b16 v[192:193], v216 offset:22528
    ds_read_b64_tr_b16 v[194:195], v216 offset:23040
    ds_read_b128 v[72:75], v234 offset:0
    v_mfma_f32_32x32x16_bf16 v[144:159], v[52:55], v[204:207], v[144:159]
    ds_read_b64_tr_b16 v[196:197], v217 offset:22528
    ds_read_b64_tr_b16 v[198:199], v217 offset:23040
    ds_read_b128 v[76:79], v235 offset:0
    s_waitcnt lgkmcnt(7)
    v_mfma_f32_32x32x16_bf16 v[128:143], v[56:59], v[208:211], v[128:143]
    ds_read_b64_tr_b16 v[200:201], v216 offset:0
    ds_read_b64_tr_b16 v[202:203], v216 offset:512
    ds_read_b128 v[80:83], v236 offset:0
    v_mfma_f32_32x32x16_bf16 v[144:159], v[56:59], v[212:215], v[144:159]
    ds_read_b64_tr_b16 v[204:205], v217 offset:0
    ds_read_b64_tr_b16 v[206:207], v217 offset:512
    ds_read_b128 v[84:87], v237 offset:0
    s_waitcnt lgkmcnt(7)
    v_mfma_f32_32x32x16_bf16 v[128:143], v[60:63], v[192:195], v[128:143]
    ds_read_b64_tr_b16 v[208:209], v216 offset:2048
    ds_read_b64_tr_b16 v[210:211], v216 offset:2560
    ds_read_b128 v[88:91], v238 offset:0
    v_mfma_f32_32x32x16_bf16 v[144:159], v[60:63], v[196:199], v[144:159]
    ds_read_b64_tr_b16 v[212:213], v217 offset:2048
    ds_read_b64_tr_b16 v[214:215], v217 offset:2560
    ds_read_b128 v[92:95], v239 offset:0
    s_waitcnt vmcnt(9)
    s_waitcnt lgkmcnt(0)
    s_barrier
    v_mfma_f32_32x32x16_bf16 v[128:143], v[64:67], v[200:203], v[128:143]
    ds_read_b64_tr_b16 v[192:193], v216 offset:4096
    ds_read_b64_tr_b16 v[194:195], v216 offset:4608
    v_and_b32 v247, 63, v255
    v_lshrrev_b32 v248, 3, v247
    v_mul_u32_u24 v218, 3584, v248
    v_and_b32 v248, 7, v247
    v_bfe_u32 v249, v247, 4, 1
    v_lshlrev_b32 v249, 1, v249
    v_xor_b32 v248, v248, v249
    v_lshl_add_u32 v218, v248, 4, v218
    v_xor_b32 v219, 64, v218
    s_mov_b32 s20, s52
    s_mov_b32 s21, s53
    s_mov_b32 s22, 1835008
    s_mov_b32 s23, 0x20000
    s_mov_b32 s24, s54
    s_mov_b32 s25, s55
    s_mov_b32 s26, 1835008
    s_mov_b32 s27, 0x20000
    s_lshl_b32 s14, s65, 7
    s_add_u32 s14, s14, 2048
    s_mul_i32 s66, s60, 28672
    s_add_u32 s14, s14, s66
    s_mov_b32 s15, s14
    s_add_u32 s66, s14, 0
    s_add_u32 m0, s69, 0
    s_nop 0
    buffer_load_dwordx4 v218, s[20:23], s66 offen lds
    v_mfma_f32_32x32x16_bf16 v[144:159], v[64:67], v[204:207], v[144:159]
    ds_read_b64_tr_b16 v[196:197], v217 offset:4096
    ds_read_b64_tr_b16 v[198:199], v217 offset:4608
    s_add_u32 s66, s15, 0
    s_add_u32 m0, s69, 8192
    s_nop 0
    buffer_load_dwordx4 v219, s[24:27], s66 offen lds
    v_mfma_f32_32x32x16_bf16 v[128:143], v[68:71], v[208:211], v[128:143]
    ds_read_b64_tr_b16 v[200:201], v216 offset:6144
    ds_read_b64_tr_b16 v[202:203], v216 offset:6656
    v_mfma_f32_32x32x16_bf16 v[144:159], v[68:71], v[212:215], v[144:159]
    ds_read_b64_tr_b16 v[204:205], v217 offset:6144
    ds_read_b64_tr_b16 v[206:207], v217 offset:6656
    s_waitcnt lgkmcnt(4)
    v_mfma_f32_32x32x16_bf16 v[128:143], v[72:75], v[192:195], v[128:143]
    v_add_u32 v216, 0x10000, v216
    v_add_u32 v217, 0x10000, v217
    ds_read_b64_tr_b16 v[208:209], v216 offset:0
    ds_read_b64_tr_b16 v[210:211], v216 offset:512
    v_mfma_f32_32x32x16_bf16 v[144:159], v[72:75], v[196:199], v[144:159]
    ds_read_b64_tr_b16 v[212:213], v217 offset:0
    ds_read_b64_tr_b16 v[214:215], v217 offset:512
    s_waitcnt lgkmcnt(4)
    v_mfma_f32_32x32x16_bf16 v[128:143], v[76:79], v[200:203], v[128:143]
    ds_read_b64_tr_b16 v[192:193], v216 offset:2048
    ds_read_b64_tr_b16 v[194:195], v216 offset:2560
    v_mfma_f32_32x32x16_bf16 v[144:159], v[76:79], v[204:207], v[144:159]
    ds_read_b64_tr_b16 v[196:197], v217 offset:2048
    ds_read_b64_tr_b16 v[198:199], v217 offset:2560
    s_waitcnt vmcnt(5)
    s_barrier
    s_waitcnt lgkmcnt(4)
    v_mfma_f32_32x32x16_bf16 v[128:143], v[80:83], v[208:211], v[128:143]
    ds_read_b64_tr_b16 v[200:201], v216 offset:4096
    ds_read_b64_tr_b16 v[202:203], v216 offset:4608
    s_add_u32 s66, s14, 229376
    s_add_u32 m0, s69, 16384
    s_nop 0
    buffer_load_dwordx4 v218, s[20:23], s66 offen lds
    ds_read_b128 v[96:99], v232 offset:32768
    v_mfma_f32_32x32x16_bf16 v[144:159], v[80:83], v[212:215], v[144:159]
    ds_read_b64_tr_b16 v[204:205], v217 offset:4096
    ds_read_b64_tr_b16 v[206:207], v217 offset:4608
    s_add_u32 s66, s15, 229376
    s_add_u32 m0, s69, 24576
    s_nop 0
    buffer_load_dwordx4 v219, s[24:27], s66 offen lds
    ds_read_b128 v[100:103], v233 offset:32768
    s_waitcnt lgkmcnt(6)
    v_mfma_f32_32x32x16_bf16 v[128:143], v[84:87], v[192:195], v[128:143]
    ds_read_b64_tr_b16 v[208:209], v216 offset:6144
    ds_read_b64_tr_b16 v[210:211], v216 offset:6656
    s_add_u32 s66, s14, 458752
    s_add_u32 m0, s69, 65536
    s_nop 0
    buffer_load_dwordx4 v218, s[20:23], s66 offen lds
    ds_read_b128 v[104:107], v234 offset:32768
    v_mfma_f32_32x32x16_bf16 v[144:159], v[84:87], v[196:199], v[144:159]
    ds_read_b64_tr_b16 v[212:213], v217 offset:6144
    ds_read_b64_tr_b16 v[214:215], v217 offset:6656
    s_add_u32 s66, s15, 458752
    s_add_u32 m0, s69, 73728
    s_nop 0
    buffer_load_dwordx4 v219, s[24:27], s66 offen lds
    ds_read_b128 v[108:111], v235 offset:32768
    s_waitcnt lgkmcnt(7)
    v_mfma_f32_32x32x16_bf16 v[128:143], v[88:91], v[200:203], v[128:143]
    v_add_u32 v216, 0xffff0000, v216
    v_add_u32 v217, 0xffff0000, v217
    ds_read_b64_tr_b16 v[192:193], v216 offset:49152
    ds_read_b64_tr_b16 v[194:195], v216 offset:49664
    ds_read_b128 v[112:115], v236 offset:32768
    v_mfma_f32_32x32x16_bf16 v[144:159], v[88:91], v[204:207], v[144:159]
    ds_read_b64_tr_b16 v[196:197], v217 offset:49152
    ds_read_b64_tr_b16 v[198:199], v217 offset:49664
    ds_read_b128 v[116:119], v237 offset:32768
    s_waitcnt lgkmcnt(7)
    v_mfma_f32_32x32x16_bf16 v[128:143], v[92:95], v[208:211], v[128:143]
    ds_read_b64_tr_b16 v[200:201], v216 offset:51200
    ds_read_b64_tr_b16 v[202:203], v216 offset:51712
    ds_read_b128 v[120:123], v238 offset:32768
    v_mfma_f32_32x32x16_bf16 v[144:159], v[92:95], v[212:215], v[144:159]
    ds_read_b64_tr_b16 v[204:205], v217 offset:51200
    ds_read_b64_tr_b16 v[206:207], v217 offset:51712
    ds_read_b128 v[124:127], v239 offset:32768
    s_waitcnt vmcnt(6)
    s_waitcnt lgkmcnt(0)
    s_barrier
    s_add_u32 s66, s63, 0
    s_lshl_b32 s66, s66, 7
    v_and_b32 v250, 15, v255
    v_lshlrev_b32 v250, 2, v250
    v_add_u32 v250, s66, v250
    buffer_load_dword v245, v250, s[36:39], 0 offen sc1
    s_add_u32 s66, s64, 16
    s_lshl_b32 s66, s66, 7
    v_and_b32 v250, 15, v255
    v_lshlrev_b32 v250, 2, v250
    v_add_u32 v250, s66, v250
    buffer_load_dword v246, v250, s[36:39], 0 offen sc1
    v_mfma_f32_32x32x16_bf16 v[128:143], v[96:99], v[192:195], v[128:143]
    ds_read_b64_tr_b16 v[208:209], v216 offset:53248
    ds_read_b64_tr_b16 v[210:211], v216 offset:53760
    s_add_u32 s66, s14, 688128
    s_add_u32 m0, s69, 32768
    s_nop 0
    buffer_load_dwordx4 v218, s[20:23], s66 offen lds
    v_mfma_f32_32x32x16_bf16 v[144:159], v[96:99], v[196:199], v[144:159]
    ds_read_b64_tr_b16 v[212:213], v217 offset:53248
    ds_read_b64_tr_b16 v[214:215], v217 offset:53760
    s_add_u32 s66, s15, 688128
    s_add_u32 m0, s69, 40960
    s_nop 0
    buffer_load_dwordx4 v219, s[24:27], s66 offen lds
    v_mfma_f32_32x32x16_bf16 v[128:143], v[100:103], v[200:203], v[128:143]
    ds_read_b64_tr_b16 v[192:193], v216 offset:55296
    ds_read_b64_tr_b16 v[194:195], v216 offset:55808
    s_add_u32 s66, s14, 917504
    s_add_u32 m0, s69, 49152
    s_nop 0
    buffer_load_dwordx4 v218, s[20:23], s66 offen lds
    v_mfma_f32_32x32x16_bf16 v[144:159], v[100:103], v[204:207], v[144:159]
    ds_read_b64_tr_b16 v[196:197], v217 offset:55296
    ds_read_b64_tr_b16 v[198:199], v217 offset:55808
    s_add_u32 s66, s15, 917504
    s_add_u32 m0, s69, 57344
    s_nop 0
    buffer_load_dwordx4 v219, s[24:27], s66 offen lds
    s_waitcnt lgkmcnt(4)
    v_mfma_f32_32x32x16_bf16 v[128:143], v[104:107], v[208:211], v[128:143]
    ds_read_b64_tr_b16 v[200:201], v216 offset:32768
    ds_read_b64_tr_b16 v[202:203], v216 offset:33280
    v_mfma_f32_32x32x16_bf16 v[144:159], v[104:107], v[212:215], v[144:159]
    ds_read_b64_tr_b16 v[204:205], v217 offset:32768
    ds_read_b64_tr_b16 v[206:207], v217 offset:33280
    s_waitcnt lgkmcnt(4)
    v_mfma_f32_32x32x16_bf16 v[128:143], v[108:111], v[192:195], v[128:143]
    ds_read_b64_tr_b16 v[208:209], v216 offset:34816
    ds_read_b64_tr_b16 v[210:211], v216 offset:35328
    v_mfma_f32_32x32x16_bf16 v[144:159], v[108:111], v[196:199], v[144:159]
    ds_read_b64_tr_b16 v[212:213], v217 offset:34816
    ds_read_b64_tr_b16 v[214:215], v217 offset:35328
    s_waitcnt vmcnt(10)
    s_barrier
    s_waitcnt lgkmcnt(4)
    v_mfma_f32_32x32x16_bf16 v[128:143], v[112:115], v[200:203], v[128:143]
    ds_read_b64_tr_b16 v[192:193], v216 offset:36864
    ds_read_b64_tr_b16 v[194:195], v216 offset:37376
    v_mfma_f32_32x32x16_bf16 v[144:159], v[112:115], v[204:207], v[144:159]
    ds_read_b64_tr_b16 v[196:197], v217 offset:36864
    ds_read_b64_tr_b16 v[198:199], v217 offset:37376
    s_waitcnt lgkmcnt(4)
    v_mfma_f32_32x32x16_bf16 v[128:143], v[116:119], v[208:211], v[128:143]
    ds_read_b64_tr_b16 v[200:201], v216 offset:38912
    ds_read_b64_tr_b16 v[202:203], v216 offset:39424
    v_mfma_f32_32x32x16_bf16 v[144:159], v[116:119], v[212:215], v[144:159]
    ds_read_b64_tr_b16 v[204:205], v217 offset:38912
    ds_read_b64_tr_b16 v[206:207], v217 offset:39424
    s_waitcnt lgkmcnt(4)
    v_mfma_f32_32x32x16_bf16 v[128:143], v[120:123], v[192:195], v[128:143]
    v_and_b32 v247, 63, v255
    v_lshrrev_b32 v248, 5, v247
    v_lshlrev_b32 v248, 3, v248
    v_bfe_u32 v249, v247, 2, 2
    v_add_u32 v248, v248, v249
    v_lshlrev_b32 v216, 7, v248
    v_bfe_u32 v248, v247, 1, 1
    v_bfe_u32 v249, v247, 4, 1
    s_lshl_b32 s66, s62, 2
    v_add_u32 v248, s66, v248
    v_lshl_add_u32 v216, v249, 13, v216
    v_lshlrev_b32 v249, 2, v249
    v_xor_b32 v248, v248, v249
    v_bfe_u32 v249, v247, 3, 1
    v_lshlrev_b32 v249, 1, v249
    v_xor_b32 v248, v248, v249
    v_lshl_add_u32 v216, v248, 4, v216
    v_and_b32 v248, 1, v247
    v_lshl_add_u32 v216, v248, 3, v216
    v_xor_b32 v217, 32, v216
    ds_read_b64_tr_b16 v[208:209], v216 offset:0
    ds_read_b64_tr_b16 v[210:211], v216 offset:512
    v_mfma_f32_32x32x16_bf16 v[144:159], v[120:123], v[196:199], v[144:159]
    ds_read_b64_tr_b16 v[212:213], v217 offset:0
    ds_read_b64_tr_b16 v[214:215], v217 offset:512
    s_waitcnt lgkmcnt(4)
    v_mfma_f32_32x32x16_bf16 v[128:143], v[124:127], v[200:203], v[128:143]
    ds_read_b64_tr_b16 v[192:193], v216 offset:2048
    ds_read_b64_tr_b16 v[194:195], v216 offset:2560
    v_mfma_f32_32x32x16_bf16 v[144:159], v[124:127], v[204:207], v[144:159]
    ds_read_b64_tr_b16 v[196:197], v217 offset:2048
    ds_read_b64_tr_b16 v[198:199], v217 offset:2560
    s_waitcnt vmcnt(6)
    s_barrier
    s_waitcnt vmcnt(5)
    v_cmp_ne_u32 vcc, 0, v245
    s_nop 3
    s_and_b32 s66, vcc_lo, 0xffff
    s_cmp_eq_u32 s66, 0xffff
    s_cbranch_scc1 L_pc6
    s_add_u32 s66, s63, 0
    s_lshl_b32 s66, s66, 7
    v_and_b32 v250, 15, v255
    v_lshlrev_b32 v250, 2, v250
    v_add_u32 v250, s66, v250
    s_mov_b32 s78, 0x40000
L_spin7:
    buffer_load_dword v251, v250, s[36:39], 0 offen sc1
    s_waitcnt vmcnt(0)
    v_cmp_ne_u32 vcc, 0, v251
    s_nop 3
    s_and_b32 s66, vcc_lo, 0xffff
    s_cmp_eq_u32 s66, 0xffff
    s_cbranch_scc1 L_spun7
    s_sleep 8
    s_sub_u32 s78, s78, 1
    s_cbranch_scc0 L_spin7
L_spun7:
L_pc6:
    s_waitcnt vmcnt(4)
    v_cmp_ne_u32 vcc, 0, v246
    s_nop 3
    s_and_b32 s66, vcc_lo, 0xffff
    s_cmp_eq_u32 s66, 0xffff
    s_cbranch_scc1 L_pc8
    s_add_u32 s66, s64, 16
    s_lshl_b32 s66, s66, 7
    v_and_b32 v250, 15, v255
    v_lshlrev_b32 v250, 2, v250
    v_add_u32 v250, s66, v250
    s_mov_b32 s78, 0x40000
L_spin9:
    buffer_load_dword v251, v250, s[36:39], 0 offen sc1
    s_waitcnt vmcnt(0)
    v_cmp_ne_u32 vcc, 0, v251
    s_nop 3
    s_and_b32 s66, vcc_lo, 0xffff
    s_cmp_eq_u32 s66, 0xffff
    s_cbranch_scc1 L_spun9
    s_sleep 8
    s_sub_u32 s78, s78, 1
    s_cbranch_scc0 L_spin9
L_spun9:
L_pc8:
    v_lshlrev_b32 v225, 3, v255
    v_mov_b32 v224, 0x7ff00000
    v_cmp_gt_u32 vcc, 128, v255
    s_nop 1
    v_cndmask_b32 v225, v224, v225, vcc
    s_lshl_b32 s68, s63, 10
    s_add_u32 s68, s68, 65536
    buffer_load_dwordx2 v[220:221], v225, s[36:39], s68 offen sc1
    v_lshlrev_b32 v223, 2, v255
    v_cmp_gt_u32 vcc, 320, v255
    s_nop 1
    v_cndmask_b32 v223, v224, v223, vcc
    s_mul_i32 s3, s64, 20480
    s_add_u32 s3, s3, 131072
    s_waitcnt lgkmcnt(4)
    v_mfma_f32_32x32x16_bf16 v[160:175], v[208:211], v[0:3], 0
    ds_read_b64_tr_b16 v[200:201], v216 offset:4096
    ds_read_b64_tr_b16 v[202:203], v216 offset:4608
    s_add_u32 s66, s14, 1146880
    s_add_u32 m0, s69, 81920
    s_nop 0
    buffer_load_dwordx4 v218, s[20:23], s66 offen lds
    s_add_u32 s68, s3, 0
    buffer_load_dword v232, v223, s[36:39], s68 offen sc1
    s_add_u32 s68, s3, 1280
    buffer_load_dword v233, v223, s[36:39], s68 offen sc1
    v_mfma_f32_32x32x16_bf16 v[176:191], v[212:215], v[0:3], 0
    ds_read_b64_tr_b16 v[204:205], v217 offset:4096
    ds_read_b64_tr_b16 v[206:207], v217 offset:4608
    s_add_u32 s66, s15, 1146880
    s_add_u32 m0, s69, 90112
    s_nop 0
    buffer_load_dwordx4 v219, s[24:27], s66 offen lds
    s_add_u32 s68, s3, 2560
    buffer_load_dword v234, v223, s[36:39], s68 offen sc1
    s_add_u32 s68, s3, 3840
    buffer_load_dword v235, v223, s[36:39], s68 offen sc1
    s_waitcnt lgkmcnt(4)
    v_mfma_f32_32x32x16_bf16 v[160:175], v[192:195], v[4:7], v[160:175]
    ds_read_b64_tr_b16 v[208:209], v216 offset:6144
    ds_read_b64_tr_b16 v[210:211], v216 offset:6656
    s_add_u32 s66, s14, 1376256
    s_add_u32 m0, s69, 98304
    s_nop 0
    buffer_load_dwordx4 v218, s[20:23], s66 offen lds
    s_add_u32 s68, s3, 5120
    buffer_load_dword v236, v223, s[36:39], s68 offen sc1
    s_add_u32 s68, s3, 6400
    buffer_load_dword v237, v223, s[36:39], s68 offen sc1
    v_mfma_f32_32x32x16_bf16 v[176:191], v[196:199], v[4:7], v[176:191]
    ds_read_b64_tr_b16 v[212:213], v217 offset:6144
    ds_read_b64_tr_b16 v[214:215], v217 offset:6656
    s_add_u32 s66, s15, 1376256
    s_add_u32 m0, s69, 106496
    s_nop 0
    buffer_load_dwordx4 v219, s[24:27], s66 offen lds
    s_add_u32 s68, s3, 7680
    buffer_load_dword v238, v223, s[36:39], s68 offen sc1
    s_add_u32 s68, s3, 8960
    buffer_load_dword v239, v223, s[36:39], s68 offen sc1
    s_waitcnt lgkmcnt(4)
    v_mfma_f32_32x32x16_bf16 v[160:175], v[200:203], v[8:11], v[160:175]
    ds_read_b64_tr_b16 v[192:193], v216 offset:16384
    ds_read_b64_tr_b16 v[194:195], v216 offset:16896
    s_add_u32 s68, s3, 10240
    buffer_load_dword v240, v223, s[36:39], s68 offen sc1
    s_add_u32 s68, s3, 11520
    buffer_load_dword v241, v223, s[36:39], s68 offen sc1
    v_mfma_f32_32x32x16_bf16 v[176:191], v[204:207], v[8:11], v[176:191]
    ds_read_b64_tr_b16 v[196:197], v217 offset:16384
    ds_read_b64_tr_b16 v[198:199], v217 offset:16896
    s_add_u32 s68, s3, 12800
    buffer_load_dword v242, v223, s[36:39], s68 offen sc1
    s_add_u32 s68, s3, 14080
    buffer_load_dword v243, v223, s[36:39], s68 offen sc1
    s_waitcnt lgkmcnt(4)
    v_mfma_f32_32x32x16_bf16 v[160:175], v[208:211], v[12:15], v[160:175]
    ds_read_b64_tr_b16 v[200:201], v216 offset:18432
    ds_read_b64_tr_b16 v[202:203], v216 offset:18944
    s_add_u32 s68, s3, 15360
    buffer_load_dword v244, v223, s[36:39], s68 offen sc1
    s_add_u32 s68, s3, 16640
    buffer_load_dword v245, v223, s[36:39], s68 offen sc1
    v_mfma_f32_32x32x16_bf16 v[176:191], v[212:215], v[12:15], v[176:191]
    ds_read_b64_tr_b16 v[204:205], v217 offset:18432
    ds_read_b64_tr_b16 v[206:207], v217 offset:18944
    s_add_u32 s68, s3, 17920
    buffer_load_dword v246, v223, s[36:39], s68 offen sc1
    s_add_u32 s68, s3, 19200
    buffer_load_dword v222, v223, s[36:39], s68 offen sc1
    s_waitcnt lgkmcnt(4)
    v_mfma_f32_32x32x16_bf16 v[160:175], v[192:195], v[16:19], v[160:175]
    ds_read_b64_tr_b16 v[208:209], v216 offset:20480
    ds_read_b64_tr_b16 v[210:211], v216 offset:20992
    v_mfma_f32_32x32x16_bf16 v[176:191], v[196:199], v[16:19], v[176:191]
    ds_read_b64_tr_b16 v[212:213], v217 offset:20480
    ds_read_b64_tr_b16 v[214:215], v217 offset:20992
    s_waitcnt lgkmcnt(4)
    v_mfma_f32_32x32x16_bf16 v[160:175], v[200:203], v[20:23], v[160:175]
    ds_read_b64_tr_b16 v[192:193], v216 offset:22528
    ds_read_b64_tr_b16 v[194:195], v216 offset:23040
    v_mfma_f32_32x32x16_bf16 v[176:191], v[204:207], v[20:23], v[176:191]
    ds_read_b64_tr_b16 v[196:197], v217 offset:22528
    ds_read_b64_tr_b16 v[198:199], v217 offset:23040
    s_waitcnt vmcnt(17)
    v_add_f32 v232, v232, v233
    s_waitcnt vmcnt(14)
    v_add_f32 v234, v234, v235
    s_waitcnt vmcnt(11)
    v_add_f32 v236, v236, v237
    s_waitcnt vmcnt(8)
    v_add_f32 v238, v238, v239
    s_waitcnt vmcnt(6)
    v_add_f32 v240, v240, v241
    s_waitcnt vmcnt(4)
    v_add_f32 v242, v242, v243
    s_waitcnt vmcnt(2)
    v_add_f32 v244, v244, v245
    s_waitcnt vmcnt(0)
    v_add_f32 v246, v246, v222
    v_add_f32 v232, v232, v234
    v_add_f32 v236, v236, v238
    v_add_f32 v240, v240, v242
    v_add_f32 v244, v244, v246
    v_add_f32 v232, v232, v236
    v_add_f32 v240, v240, v244
    v_add_f32 v232, v232, v240
    v_lshlrev_b32 v223, 2, v255
    v_add_u32 v224, 0x24000, v223
    v_add_u32 v225, 0x24c00, v223
    v_mov_b32 v223, 0
    v_cmp_gt_u32 vcc, 320, v255
    s_nop 1
    s_and_saveexec_b64 s[76:77], vcc
    ds_write_b32 v224, v232
    s_mov_b64 exec, s[76:77]
    v_cmp_gt_u32 vcc, 384, v255
    s_nop 1
    s_and_saveexec_b64 s[76:77], vcc
    ds_write_b32 v224, v223 offset:1536
    s_mov_b64 exec, s[76:77]
    v_cmp_gt_u32 vcc, 128, v255
    s_nop 1
    s_and_saveexec_b64 s[76:77], vcc
    ds_write_b32 v225, v221
    ds_write_b32 v225, v220 offset:512
    s_mov_b64 exec, s[76:77]
    s_waitcnt lgkmcnt(8)
    v_mfma_f32_32x32x16_bf16 v[160:175], v[208:211], v[24:27], v[160:175]
    v_add_u32 v216, 0x10000, v216
    v_add_u32 v217, 0x10000, v217
    ds_read_b64_tr_b16 v[200:201], v216 offset:0
    ds_read_b64_tr_b16 v[202:203], v216 offset:512
    v_mfma_f32_32x32x16_bf16 v[176:191], v[212:215], v[24:27], v[176:191]
    ds_read_b64_tr_b16 v[204:205], v217 offset:0
    ds_read_b64_tr_b16 v[206:207], v217 offset:512
    s_waitcnt lgkmcnt(8)
    v_mfma_f32_32x32x16_bf16 v[160:175], v[192:195], v[28:31], v[160:175]
    ds_read_b64_tr_b16 v[208:209], v216 offset:2048
    ds_read_b64_tr_b16 v[210:211], v216 offset:2560
    v_mfma_f32_32x32x16_bf16 v[176:191], v[196:199], v[28:31], v[176:191]
    ds_read_b64_tr_b16 v[212:213], v217 offset:2048
    ds_read_b64_tr_b16 v[214:215], v217 offset:2560
    s_waitcnt lgkmcnt(0)
    s_barrier
    v_and_b32 v232, 31, v255
    s_lshl_b32 s66, s61, 5
    v_add_u32 v232, s66, v232
    v_lshlrev_b32 v232, 2, v232
    v_add_u32 v232, 0x24c00, v232
    ds_read_b32 v223, v232
    ds_read_b32 v233, v232 offset:512
    s_waitcnt lgkmcnt(1)
    v_mul_f32 v220, s72, v223
    v_mul_f32 v222, v223, v223
    v_mul_f32 v221, v220, v222
    v_mul_f32 v221, 0x3d372713, v221
    v_rcp_f32 v222, v222
    s_waitcnt lgkmcnt(0)
    v_cvt_pk_bf16_f32 v234, v233, v233
    v_lshlrev_b32 v235, 16, v234
    v_sub_f32 v235, v233, v235
    v_cvt_pk_bf16_f32 v228, v233, v235
    v_cvt_pk_bf16_f32 v229, v233, 0
    v_mov_b32 v234, 0
    s_mov_b32 s100, 0
    s_mov_b32 s101, -1
    v_cndmask_b32 v228, v228, v234, s[100:101]
    v_cndmask_b32 v229, v229, v234, s[100:101]
    v_mfma_f32_32x32x16_bf16 v[160:175], v[200:203], v[32:35], v[160:175]
    ds_read_b64_tr_b16 v[192:193], v216 offset:4096
    ds_read_b64_tr_b16 v[194:195], v216 offset:4608
    s_add_u32 s66, s14, 1605632
    s_add_u32 m0, s69, 0
    s_nop 0
    buffer_load_dwordx4 v218, s[20:23], s66 offen lds
    v_and_b32 v248, 31, v255
    v_lshlrev_b32 v248, 2, v248
    s_lshl_b32 s67, s62, 7
    s_add_u32 s67, s67, 147456
    v_add_u32 v252, s67, v248
    v_mov_b32 v248, 0x24600
    s_mov_b32 s100, 0
    s_mov_b32 s101, -1
    v_cndmask_b32 v252, v252, v248, s[100:101]
    v_mfma_f32_32x32x16_bf16 v[176:191], v[204:207], v[32:35], v[176:191]
    ds_read_b64_tr_b16 v[196:197], v217 offset:4096
    ds_read_b64_tr_b16 v[198:199], v217 offset:4608
    s_add_u32 s66, s15, 1605632
    s_add_u32 m0, s69, 8192
    s_nop 0
    buffer_load_dwordx4 v219, s[24:27], s66 offen lds
    ds_read_b32 v240, v252 offset:0
    ds_read_b32 v242, v252 offset:256
    v_bfe_u32 v246, v255, 5, 1
    v_lshlrev_b32 v246, 4, v246
    s_lshl_b32 s67, s61, 7
    s_add_u32 s67, s67, 150528
    v_add_u32 v246, s67, v246
    ds_read_b128 v[232:235], v246
    v_mfma_f32_32x32x16_bf16 v[160:175], v[208:211], v[36:39], v[160:175]
    ds_read_b64_tr_b16 v[200:201], v216 offset:6144
    ds_read_b64_tr_b16 v[202:203], v216 offset:6656
    v_and_b32 v247, 63, v255
    v_lshrrev_b32 v248, 2, v247
    v_mul_u32_u24 v218, 3584, v248
    v_and_b32 v248, 3, v247
    v_lshl_add_u32 v218, v248, 4, v218
    v_xor_b32 v219, 32, v218
    s_mov_b32 s20, s52
    s_mov_b32 s21, s53
    s_mov_b32 s22, 1835008
    s_mov_b32 s23, 0x20000
    s_mov_b32 s24, s54
    s_mov_b32 s25, s55
    s_mov_b32 s26, 1835008
    s_mov_b32 s27, 0x20000
    s_lshr_b32 s14, s65, 1
    s_lshl_b32 s14, s14, 7
    s_and_b32 s66, s65, 1
    s_lshl_b32 s66, s66, 6
    s_add_u32 s14, s14, s66
    s_add_u32 s14, s14, 3072
    s_mul_i32 s66, s60, 57344
    s_add_u32 s14, s14, s66
    s_mov_b32 s15, s14
    s_add_u32 s66, s14, 0
    s_add_u32 m0, s69, 16384
    s_nop 0
    buffer_load_dwordx4 v218, s[20:23], s66 offen lds
    v_mfma_f32_32x32x16_bf16 v[176:191], v[212:215], v[36:39], v[176:191]
    ds_read_b64_tr_b16 v[204:205], v217 offset:6144
    ds_read_b64_tr_b16 v[206:207], v217 offset:6656
    s_add_u32 s66, s15, 0
    s_add_u32 m0, s69, 24576
    s_nop 0
    buffer_load_dwordx4 v219, s[24:27], s66 offen lds
    ds_read_b128 v[236:239], v246 offset:32
    s_waitcnt lgkmcnt(8)
    v_mfma_f32_32x32x16_bf16 v[160:175], v[192:195], v[40:43], v[160:175]
    v_add_u32 v216, 0xffff0000, v216
    v_add_u32 v217, 0xffff0000, v217
    ds_read_b64_tr_b16 v[208:209], v216 offset:32768
    ds_read_b64_tr_b16 v[210:211], v216 offset:33280
    v_mfma_f32_32x32x16_bf16 v[176:191], v[196:199], v[40:43], v[176:191]
    ds_read_b64_tr_b16 v[212:213], v217 offset:32768
    ds_read_b64_tr_b16 v[214:215], v217 offset:33280
    s_waitcnt lgkmcnt(5)
    v_mfma_f32_32x32x16_bf16 v[160:175], v[200:203], v[44:47], v[160:175]
    ds_read_b64_tr_b16 v[192:193], v216 offset:34816
    ds_read_b64_tr_b16 v[194:195], v216 offset:35328
    v_cvt_pk_bf16_f32 v224, v240, v240
    v_lshlrev_b32 v241, 16, v224
    v_sub_f32 v241, v240, v241
    v_cvt_pk_bf16_f32 v225, v241, 0
    s_nop 1
    v_mfma_f32_32x32x16_bf16 v[128:143], v[228:231], v[224:227], v[128:143]
    v_mfma_f32_32x32x16_bf16 v[176:191], v[204:207], v[44:47], v[176:191]
    ds_read_b64_tr_b16 v[196:197], v217 offset:34816
    ds_read_b64_tr_b16 v[198:199], v217 offset:35328
    v_cvt_pk_bf16_f32 v224, v242, v242
    v_lshlrev_b32 v243, 16, v224
    v_sub_f32 v243, v242, v243
    v_cvt_pk_bf16_f32 v225, v243, 0
    s_nop 1
    v_mfma_f32_32x32x16_bf16 v[144:159], v[228:231], v[224:227], v[144:159]
    s_waitcnt lgkmcnt(4)
    v_mfma_f32_32x32x16_bf16 v[160:175], v[208:211], v[48:51], v[160:175]
    ds_read_b64_tr_b16 v[200:201], v216 offset:36864
    ds_read_b64_tr_b16 v[202:203], v216 offset:37376
    v_mfma_f32_32x32x16_bf16 v[176:191], v[212:215], v[48:51], v[176:191]
    ds_read_b64_tr_b16 v[204:205], v217 offset:36864
    ds_read_b64_tr_b16 v[206:207], v217 offset:37376
    s_waitcnt lgkmcnt(4)
    v_mfma_f32_32x32x16_bf16 v[160:175], v[192:195], v[52:55], v[160:175]
    ds_read_b64_tr_b16 v[208:209], v216 offset:38912
    ds_read_b64_tr_b16 v[210:211], v216 offset:39424
    v_mul_f32 v128, v128, v232
    v_mul_f32 v129, v129, v233
    v_mul_f32 v130, v130, v234
    v_mul_f32 v131, v131, v235
    v_mul_f32 v132, v132, v236
    v_mfma_f32_32x32x16_bf16 v[176:191], v[196:199], v[52:55], v[176:191]
    ds_read_b64_tr_b16 v[212:213], v217 offset:38912
    ds_read_b64_tr_b16 v[214:215], v217 offset:39424
    v_mul_f32 v133, v133, v237
    v_mul_f32 v134, v134, v238
    v_mul_f32 v135, v135, v239
    v_mul_f32 v144, v144, v232
    v_mul_f32 v145, v145, v233
    v_mul_f32 v146, v146, v234
    s_waitcnt lgkmcnt(4)
    v_mfma_f32_32x32x16_bf16 v[160:175], v[200:203], v[56:59], v[160:175]
    ds_read_b64_tr_b16 v[192:193], v216 offset:49152
    ds_read_b64_tr_b16 v[194:195], v216 offset:49664
    v_mul_f32 v147, v147, v235
    v_mul_f32 v148, v148, v236
    v_mul_f32 v149, v149, v237
    v_mfma_f32_32x32x16_bf16 v[176:191], v[204:207], v[56:59], v[176:191]
    ds_read_b64_tr_b16 v[196:197], v217 offset:49152
    ds_read_b64_tr_b16 v[198:199], v217 offset:49664
    v_mul_f32 v150, v150, v238
    v_mul_f32 v151, v151, v239
    ds_read_b128 v[232:235], v246 offset:64
    ds_read_b128 v[236:239], v246 offset:96
    s_waitcnt lgkmcnt(6)
    v_mfma_f32_32x32x16_bf16 v[160:175], v[208:211], v[60:63], v[160:175]
    ds_read_b64_tr_b16 v[200:201], v216 offset:51200
    ds_read_b64_tr_b16 v[202:203], v216 offset:51712
    v_mfma_f32_32x32x16_bf16 v[176:191], v[212:215], v[60:63], v[176:191]
    ds_read_b64_tr_b16 v[204:205], v217 offset:51200
    ds_read_b64_tr_b16 v[206:207], v217 offset:51712
    s_barrier
    s_waitcnt lgkmcnt(6)
    v_mfma_f32_32x32x16_bf16 v[160:175], v[192:195], v[64:67], v[160:175]
    ds_read_b64_tr_b16 v[208:209], v216 offset:53248
    ds_read_b64_tr_b16 v[210:211], v216 offset:53760
    s_add_u32 s66, s14, 458752
    s_add_u32 m0, s69, 32768
    s_nop 0
    buffer_load_dwordx4 v218, s[20:23], s66 offen lds
    s_waitcnt lgkmcnt(7)
    v_mul_f32 v136, v136, v232
    v_mul_f32 v137, v137, v233
    v_mul_f32 v138, v138, v234
    v_mul_f32 v139, v139, v235
    s_waitcnt lgkmcnt(6)
    v_mul_f32 v140, v140, v236
    v_mfma_f32_32x32x16_bf16 v[176:191], v[196:199], v[64:67], v[176:191]
    ds_read_b64_tr_b16 v[212:213], v217 offset:53248
    ds_read_b64_tr_b16 v[214:215], v217 offset:53760
    s_add_u32 s66, s15, 458752
    s_add_u32 m0, s69, 40960
    s_nop 0
    buffer_load_dwordx4 v219, s[24:27], s66 offen lds
    v_mul_f32 v141, v141, v237
    v_mul_f32 v142, v142, v238
    v_mul_f32 v143, v143, v239
    v_mul_f32 v152, v152, v232
    v_mul_f32 v153, v153, v233
    v_mul_f32 v154, v154, v234
    s_waitcnt lgkmcnt(4)
    v_mfma_f32_32x32x16_bf16 v[160:175], v[200:203], v[68:71], v[160:175]
    ds_read_b64_tr_b16 v[192:193], v216 offset:55296
    ds_read_b64_tr_b16 v[194:195], v216 offset:55808
    s_add_u32 s66, s14, 917504
    s_add_u32 m0, s69, 65536
    s_nop 0
    buffer_load_dwordx4 v218, s[20:23], s66 offen lds
    v_mul_f32 v155, v155, v235
    v_mul_f32 v156, v156, v236
    v_mul_f32 v157, v157, v237
    v_mul_f32 v158, v158, v238
    v_mul_f32 v159, v159, v239
    v_mul_f32 v232, s70, v128
    v_mfma_f32_32x32x16_bf16 v[176:191], v[204:207], v[68:71], v[176:191]
    ds_read_b64_tr_b16 v[196:197], v217 offset:55296
    ds_read_b64_tr_b16 v[198:199], v217 offset:55808
    s_add_u32 s66, s15, 917504
    s_add_u32 m0, s69, 73728
    s_nop 0
    buffer_load_dwordx4 v219, s[24:27], s66 offen lds
    v_mul_f32 v233, s70, v129
    v_mul_f32 v234, s70, v130
    v_mul_f32 v235, s70, v131
    v_mul_f32 v236, s70, v132
    v_mul_f32 v237, s70, v133
    v_mul_f32 v238, s70, v134
    s_waitcnt lgkmcnt(4)
    v_mfma_f32_32x32x16_bf16 v[160:175], v[208:211], v[72:75], v[160:175]
    v_add_u32 v216, 0x10000, v216
    v_add_u32 v217, 0x10000, v217
    ds_read_b64_tr_b16 v[200:201], v216 offset:16384
    ds_read_b64_tr_b16 v[202:203], v216 offset:16896
    v_mul_f32 v239, s70, v135
    v_min_f32 v232, 0, v232
    v_min_f32 v233, 0, v233
    v_min_f32 v234, 0, v234
    v_min_f32 v235, 0, v235
    v_mfma_f32_32x32x16_bf16 v[176:191], v[212:215], v[72:75], v[176:191]
    ds_read_b64_tr_b16 v[204:205], v217 offset:16384
    ds_read_b64_tr_b16 v[206:207], v217 offset:16896
    v_min_f32 v236, 0, v236
    v_min_f32 v237, 0, v237
    v_min_f32 v238, 0, v238
    v_min_f32 v239, 0, v239
    v_exp_f32 v232, v232
    v_exp_f32 v233, v233
    s_waitcnt lgkmcnt(4)
    v_mfma_f32_32x32x16_bf16 v[160:175], v[192:195], v[76:79], v[160:175]
    ds_read_b64_tr_b16 v[208:209], v216 offset:18432
    ds_read_b64_tr_b16 v[210:211], v216 offset:18944
    v_exp_f32 v234, v234
    v_exp_f32 v235, v235
    v_exp_f32 v236, v236
    v_exp_f32 v237, v237
    v_exp_f32 v238, v238
    v_exp_f32 v239, v239
    v_mfma_f32_32x32x16_bf16 v[176:191], v[196:199], v[76:79], v[176:191]
    ds_read_b64_tr_b16 v[212:213], v217 offset:18432
    ds_read_b64_tr_b16 v[214:215], v217 offset:18944
    v_max_f32 v128, 0, v128
    v_max_f32 v129, 0, v129
    v_max_f32 v130, 0, v130
    v_max_f32 v131, 0, v131
    v_max_f32 v132, 0, v132
    v_max_f32 v133, 0, v133
    s_waitcnt lgkmcnt(4)
    v_mfma_f32_32x32x16_bf16 v[160:175], v[200:203], v[80:83], v[160:175]
    ds_read_b64_tr_b16 v[192:193], v216 offset:20480
    ds_read_b64_tr_b16 v[194:195], v216 offset:20992
    v_max_f32 v134, 0, v134
    v_max_f32 v135, 0, v135
    v_add_f32 v232, s71, v232
    v_add_f32 v233, s71, v233
    v_add_f32 v234, s71, v234
    v_mfma_f32_32x32x16_bf16 v[176:191], v[204:207], v[80:83], v[176:191]
    ds_read_b64_tr_b16 v[196:197], v217 offset:20480
    ds_read_b64_tr_b16 v[198:199], v217 offset:20992
    v_add_f32 v235, s71, v235
    v_add_f32 v236, s71, v236
    v_add_f32 v237, s71, v237
    v_add_f32 v238, s71, v238
    v_add_f32 v239, s71, v239
    v_add_f32 v128, v128, v232
    s_waitcnt lgkmcnt(4)
    v_mfma_f32_32x32x16_bf16 v[160:175], v[208:211], v[84:87], v[160:175]
    ds_read_b64_tr_b16 v[200:201], v216 offset:22528
    ds_read_b64_tr_b16 v[202:203], v216 offset:23040
    v_add_f32 v129, v129, v233
    v_add_f32 v130, v130, v234
    v_add_f32 v131, v131, v235
    v_add_f32 v132, v132, v236
    v_add_f32 v133, v133, v237
    v_add_f32 v134, v134, v238
    v_mfma_f32_32x32x16_bf16 v[176:191], v[212:215], v[84:87], v[176:191]
    ds_read_b64_tr_b16 v[204:205], v217 offset:22528
    ds_read_b64_tr_b16 v[206:207], v217 offset:23040
    v_add_f32 v135, v135, v239
    v_mul_f32 v232, s70, v136
    v_mul_f32 v233, s70, v137
    v_mul_f32 v234, s70, v138
    v_mul_f32 v235, s70, v139
    v_mul_f32 v236, s70, v140
    s_waitcnt lgkmcnt(4)
    v_mfma_f32_32x32x16_bf16 v[160:175], v[192:195], v[88:91], v[160:175]
    ds_read_b64_tr_b16 v[208:209], v216 offset:32768
    ds_read_b64_tr_b16 v[210:211], v216 offset:33280
    v_mul_f32 v237, s70, v141
    v_mul_f32 v238, s70, v142
    v_mul_f32 v239, s70, v143
    v_min_f32 v232, 0, v232
    v_min_f32 v233, 0, v233
    v_mfma_f32_32x32x16_bf16 v[176:191], v[196:199], v[88:91], v[176:191]
    ds_read_b64_tr_b16 v[212:213], v217 offset:32768
    ds_read_b64_tr_b16 v[214:215], v217 offset:33280
    v_min_f32 v234, 0, v234
    v_min_f32 v235, 0, v235
    v_min_f32 v236, 0, v236
    v_min_f32 v237, 0, v237
    v_min_f32 v238, 0, v238
    v_min_f32 v239, 0, v239
    s_waitcnt lgkmcnt(4)
    v_mfma_f32_32x32x16_bf16 v[160:175], v[200:203], v[92:95], v[160:175]
    ds_read_b64_tr_b16 v[192:193], v216 offset:34816
    ds_read_b64_tr_b16 v[194:195], v216 offset:35328
    v_exp_f32 v232, v232
    v_exp_f32 v233, v233
    v_exp_f32 v234, v234
    v_exp_f32 v235, v235
    v_exp_f32 v236, v236
    v_exp_f32 v237, v237
    v_mfma_f32_32x32x16_bf16 v[176:191], v[204:207], v[92:95], v[176:191]
    ds_read_b64_tr_b16 v[196:197], v217 offset:34816
    ds_read_b64_tr_b16 v[198:199], v217 offset:35328
    v_exp_f32 v238, v238
    v_exp_f32 v239, v239
    v_max_f32 v136, 0, v136
    v_max_f32 v137, 0, v137
    v_max_f32 v138, 0, v138
    v_max_f32 v139, 0, v139
    s_waitcnt vmcnt(4)
    s_barrier
    s_waitcnt lgkmcnt(4)
    v_mfma_f32_32x32x16_bf16 v[160:175], v[208:211], v[96:99], v[160:175]
    ds_read_b64_tr_b16 v[200:201], v216 offset:36864
    ds_read_b64_tr_b16 v[202:203], v216 offset:37376
    s_add_u32 s66, s14, 1376256
    s_add_u32 m0, s69, 49152
    s_nop 0
    buffer_load_dwordx4 v218, s[20:23], s66 offen lds
    v_max_f32 v140, 0, v140
    v_max_f32 v141, 0, v141
    v_max_f32 v142, 0, v142
    v_max_f32 v143, 0, v143
    v_add_f32 v232, s71, v232
    v_mfma_f32_32x32x16_bf16 v[176:191], v[212:215], v[96:99], v[176:191]
    ds_read_b64_tr_b16 v[204:205], v217 offset:36864
    ds_read_b64_tr_b16 v[206:207], v217 offset:37376
    s_add_u32 s66, s15, 1376256
    s_add_u32 m0, s69, 57344
    s_nop 0
    buffer_load_dwordx4 v219, s[24:27], s66 offen lds
    v_add_f32 v233, s71, v233
    v_add_f32 v234, s71, v234
    v_add_f32 v235, s71, v235
    v_add_f32 v236, s71, v236
    v_add_f32 v237, s71, v237
    v_add_f32 v238, s71, v238
    s_waitcnt lgkmcnt(4)
    v_mfma_f32_32x32x16_bf16 v[160:175], v[192:195], v[100:103], v[160:175]
    ds_read_b64_tr_b16 v[208:209], v216 offset:38912
    ds_read_b64_tr_b16 v[210:211], v216 offset:39424
    v_and_b32 v247, 63, v255
    v_lshrrev_b32 v248, 3, v247
    v_lshlrev_b32 v253, 10, v248
    v_and_b32 v248, 7, v247
    v_bfe_u32 v249, v247, 4, 1
    v_lshlrev_b32 v249, 2, v249
    v_xor_b32 v248, v248, v249
    v_lshl_add_u32 v253, v248, 4, v253
    s_lshl_b32 s66, s75, 7
    v_add_u32 v253, s66, v253
    s_mov_b32 s40, s8
    s_mov_b32 s41, s9
    s_mov_b32 s42, 1835008
    s_mov_b32 s43, 0x20000
    s_mov_b32 s44, s12
    s_mov_b32 s45, s13
    s_mov_b32 s46, 524288
    s_mov_b32 s47, 0x20000
    s_mul_i32 s50, s48, 28
    s_add_u32 s50, s50, s49
    s_lshl_b32 s50, s50, 14
    s_lshl_b32 s51, s48, 3
    s_add_u32 s51, s51, s49
    s_lshl_b32 s51, s51, 14
    s_lshl_b32 s73, s48, 12
    s_lshl_b32 s66, s49, 11
    s_add_u32 s73, s73, s66
    s_add_u32 s66, s50, 0
    s_add_u32 m0, s73, 81920
    s_nop 0
    buffer_load_dwordx4 v253, s[40:43], s66 offen lds
    v_add_f32 v239, s71, v239
    v_add_f32 v136, v136, v232
    v_add_f32 v137, v137, v233
    v_add_f32 v138, v138, v234
    v_add_f32 v139, v139, v235
    v_add_f32 v140, v140, v236
    v_mfma_f32_32x32x16_bf16 v[176:191], v[196:199], v[100:103], v[176:191]
    ds_read_b64_tr_b16 v[212:213], v217 offset:38912
    ds_read_b64_tr_b16 v[214:215], v217 offset:39424
    s_add_u32 s66, s50, 8192
    s_add_u32 m0, s73, 82944
    s_nop 0
    buffer_load_dwordx4 v253, s[40:43], s66 offen lds
    v_add_f32 v141, v141, v237
    v_add_f32 v142, v142, v238
    v_add_f32 v143, v143, v239
    v_add_f32 v240, v128, v129
    v_add_f32 v241, v130, v131
    v_add_f32 v240, v240, v132
    s_waitcnt lgkmcnt(4)
    v_mfma_f32_32x32x16_bf16 v[160:175], v[200:203], v[104:107], v[160:175]
    v_add_u32 v216, 0xffff0000, v216
    v_add_u32 v217, 0xffff0000, v217
    ds_read_b64_tr_b16 v[192:193], v216 offset:0
    ds_read_b64_tr_b16 v[194:195], v216 offset:512
    v_add_f32 v241, v241, v133
    v_add_f32 v240, v240, v134
    v_add_f32 v241, v241, v135
    v_add_f32 v240, v240, v136
    v_add_f32 v241, v241, v137
    v_mfma_f32_32x32x16_bf16 v[176:191], v[204:207], v[104:107], v[176:191]
    ds_read_b64_tr_b16 v[196:197], v217 offset:0
    ds_read_b64_tr_b16 v[198:199], v217 offset:512
    v_add_f32 v240, v240, v138
    v_add_f32 v241, v241, v139
    v_add_f32 v240, v240, v140
    v_add_f32 v241, v241, v141
    v_add_f32 v240, v240, v142
    v_add_f32 v241, v241, v143
    s_waitcnt lgkmcnt(4)
    v_mfma_f32_32x32x16_bf16 v[160:175], v[208:211], v[108:111], v[160:175]
    ds_read_b64_tr_b16 v[200:201], v216 offset:2048
    ds_read_b64_tr_b16 v[202:203], v216 offset:2560
    v_add_f32 v240, v240, v241
    v_cvt_pk_bf16_f32 v128, v128, v129
    v_cvt_pk_bf16_f32 v129, v130, v131
    v_cvt_pk_bf16_f32 v130, v132, v133
    v_cvt_pk_bf16_f32 v131, v134, v135
    v_cvt_pk_bf16_f32 v132, v136, v137
    v_mfma_f32_32x32x16_bf16 v[176:191], v[212:215], v[108:111], v[176:191]
    ds_read_b64_tr_b16 v[204:205], v217 offset:2048
    ds_read_b64_tr_b16 v[206:207], v217 offset:2560
    v_cvt_pk_bf16_f32 v133, v138, v139
    v_cvt_pk_bf16_f32 v134, v140, v141
    v_cvt_pk_bf16_f32 v135, v142, v143
    v_cvt_pk_bf16_f32 v136, v144, v145
    v_cvt_pk_bf16_f32 v137, v146, v147
    v_cvt_pk_bf16_f32 v138, v148, v149
    s_waitcnt lgkmcnt(4)
    v_mfma_f32_32x32x16_bf16 v[160:175], v[192:195], v[112:115], v[160:175]
    ds_read_b64_tr_b16 v[208:209], v216 offset:4096
    ds_read_b64_tr_b16 v[210:211], v216 offset:4608
    v_cvt_pk_bf16_f32 v139, v150, v151
    v_cvt_pk_bf16_f32 v140, v152, v153
    v_cvt_pk_bf16_f32 v141, v154, v155
    v_cvt_pk_bf16_f32 v142, v156, v157
    v_cvt_pk_bf16_f32 v143, v158, v159
    v_mfma_f32_32x32x16_bf16 v[176:191], v[196:199], v[112:115], v[176:191]
    ds_read_b64_tr_b16 v[212:213], v217 offset:4096
    ds_read_b64_tr_b16 v[214:215], v217 offset:4608
    v_mfma_f32_32x32x16_bf16 v[144:159], v[128:131], v[136:139], 0
    v_mfma_f32_32x32x16_bf16 v[144:159], v[132:135], v[140:143], v[144:159]
    v_and_b32 v246, 63, v255
    v_lshlrev_b32 v245, 2, v246
    v_lshlrev_b32 v246, 5, v246
    s_lshl_b32 s67, s61, 1
    s_add_u32 s67, s67, s62
    s_mul_i32 s67, s67, 2304
    s_add_u32 s67, s67, 114688
    v_add_u32 v245, s67, v245
    v_add_u32 v246, s67, v246
    s_waitcnt lgkmcnt(4)
    v_mfma_f32_32x32x16_bf16 v[160:175], v[200:203], v[116:119], v[160:175]
    ds_read_b64_tr_b16 v[192:193], v216 offset:6144
    ds_read_b64_tr_b16 v[194:195], v216 offset:6656
    ds_write_b32 v245, v240 offset:2048
    s_mov_b32 s100, 0xffff0000
    s_mov_b32 s101, 0xffff0000
    v_cndmask_b32 v144, v144, v152, s[100:101]
    v_cndmask_b32 v145, v145, v153, s[100:101]
    v_cndmask_b32 v146, v146, v154, s[100:101]
    v_cndmask_b32 v147, v147, v155, s[100:101]
    v_cndmask_b32 v148, v148, v156, s[100:101]
    v_cndmask_b32 v149, v149, v157, s[100:101]
    v_cndmask_b32 v150, v150, v158, s[100:101]
    v_cndmask_b32 v151, v151, v159, s[100:101]
    v_mfma_f32_32x32x16_bf16 v[176:191], v[204:207], v[116:119], v[176:191]
    ds_read_b64_tr_b16 v[196:197], v217 offset:6144
    ds_read_b64_tr_b16 v[198:199], v217 offset:6656
    ds_write_b128 v246, v[144:147]
    ds_write_b128 v246, v[148:151] offset:16
    s_waitcnt lgkmcnt(7)
    v_mfma_f32_32x32x16_bf16 v[160:175], v[208:211], v[120:123], v[160:175]
    v_and_b32 v247, 63, v255
    v_lshrrev_b32 v248, 5, v247
    v_lshlrev_b32 v248, 3, v248
    v_bfe_u32 v249, v247, 2, 2
    v_add_u32 v248, v248, v249
    v_lshlrev_b32 v216, 6, v248
    v_bfe_u32 v248, v247, 1, 1
    v_bfe_u32 v249, v247, 4, 1
    s_lshl_b32 s66, s62, 1
    v_add_u32 v248, s66, v248
    v_lshl_add_u32 v216, v249, 13, v216
    v_lshlrev_b32 v249, 1, v249
    v_xor_b32 v248, v248, v249
    v_lshl_add_u32 v216, v248, 4, v216
    v_and_b32 v248, 1, v247
    v_lshl_add_u32 v216, v248, 3, v216
    ds_read_b64_tr_b16 v[200:201], v216 offset:16384
    ds_read_b64_tr_b16 v[202:203], v216 offset:16640
    v_mfma_f32_32x32x16_bf16 v[176:191], v[212:215], v[120:123], v[176:191]
    ds_read_b64_tr_b16 v[204:205], v216 offset:17408
    ds_read_b64_tr_b16 v[206:207], v216 offset:17664
    s_waitcnt lgkmcnt(6)
    v_mfma_f32_32x32x16_bf16 v[160:175], v[192:195], v[124:127], v[160:175]
    ds_read_b64_tr_b16 v[208:209], v216 offset:18432
    ds_read_b64_tr_b16 v[210:211], v216 offset:18688
    v_mfma_f32_32x32x16_bf16 v[176:191], v[196:199], v[124:127], v[176:191]
    ds_read_b64_tr_b16 v[212:213], v216 offset:19456
    ds_read_b64_tr_b16 v[214:215], v216 offset:19712
    s_waitcnt vmcnt(4)
    s_barrier
    s_waitcnt lgkmcnt(0)
    s_barrier
    v_bfe_u32 v232, v255, 2, 5
    v_and_b32 v233, 1, v255
    v_lshl_add_u32 v232, v233, 5, v232
    v_lshlrev_b32 v232, 5, v232
    v_bfe_u32 v233, v255, 1, 1
    v_lshl_add_u32 v232, v233, 4, v232
    v_bfe_u32 v233, v255, 7, 1
    v_mul_u32_u24 v233, 2304, v233
    v_add_u32 v232, v232, v233
    v_and_b32 v233, 7, v255
    v_lshlrev_b32 v233, 4, v233
    v_bfe_u32 v234, v255, 3, 1
    v_mul_u32_u24 v234, 2304, v234
    v_add_u32 v233, v233, v234
    v_add_u32 v233, 2048, v233
    v_cmp_gt_u32 vcc, 256, v255
    s_nop 1
    v_cndmask_b32 v232, v233, v232, vcc
    v_add_u32 v232, 0x1c000, v232
    v_mov_b32 v234, 1.0
    v_mov_b32 v235, 0
    v_cndmask_b32 v234, v234, v235, vcc
    ds_read_b128 v[128:131], v232 offset:0
    ds_read_b128 v[144:147], v232 offset:128
    ds_read_b128 v[132:135], v232 offset:4608
    ds_read_b128 v[148:151], v232 offset:4736
    ds_read_b128 v[136:139], v232 offset:9216
    ds_read_b128 v[152:155], v232 offset:9344
    ds_read_b128 v[140:143], v232 offset:13824
    ds_read_b128 v[156:159], v232 offset:13952
    v_lshlrev_b32 v236, 4, v255
    v_mov_b32 v237, 0x7ff00000
    v_cmp_gt_u32 vcc, 272, v255
    s_nop 1
    v_cndmask_b32 v236, v237, v236, vcc
    s_waitcnt lgkmcnt(5)
    v_add_f32 v128, v128, v132
    s_waitcnt lgkmcnt(1)
    v_add_f32 v136, v136, v140
    v_add_f32 v129, v129, v133
    v_add_f32 v137, v137, v141
    v_add_f32 v130, v130, v134
    v_add_f32 v138, v138, v142
    v_add_f32 v131, v131, v135
    v_add_f32 v139, v139, v143
    v_add_f32 v128, v128, v136
    v_add_f32 v129, v129, v137
    v_add_f32 v130, v130, v138
    v_add_f32 v131, v131, v139
    v_add_f32 v144, v144, v148
    s_waitcnt lgkmcnt(0)
    v_add_f32 v152, v152, v156
    v_add_f32 v145, v145, v149
    v_add_f32 v153, v153, v157
    v_add_f32 v146, v146, v150
    v_add_f32 v154, v154, v158
    v_add_f32 v147, v147, v151
    v_add_f32 v155, v155, v159
    v_add_f32 v144, v144, v152
    v_add_f32 v145, v145, v153
    v_add_f32 v146, v146, v154
    v_add_f32 v147, v147, v155
    v_fma_f32 v128, v144, v234, v128
    v_fma_f32 v129, v145, v234, v129
    v_fma_f32 v130, v146, v234, v130
    v_fma_f32 v131, v147, v234, v131
    s_mul_i32 s66, s63, 4352
    buffer_store_dwordx4 v[128:131], v236, s[32:35], s66 offen sc1
    v_mfma_f32_32x32x16_bf16 v[128:143], v[200:203], v[0:3], 0
    ds_read_b64_tr_b16 v[192:193], v216 offset:20480
    ds_read_b64_tr_b16 v[194:195], v216 offset:20736
    s_add_u32 s66, s50, 32768
    s_add_u32 m0, s73, 0
    s_nop 0
    buffer_load_dwordx4 v253, s[40:43], s66 offen lds
    s_lshl_b32 s3, s65, 2
    s_lshl_b32 s67, s62, 1
    s_add_u32 s3, s3, s67
    s_lshl_b32 s3, s3, 10
    v_bfe_u32 v248, v255, 4, 1
    v_lshlrev_b32 v248, 8, v248
    v_and_b32 v249, 15, v255
    v_lshl_add_u32 v248, v249, 2, v248
    v_mfma_f32_32x32x16_bf16 v[128:143], v[204:207], v[4:7], v[128:143]
    ds_read_b64_tr_b16 v[196:197], v216 offset:21504
    ds_read_b64_tr_b16 v[198:199], v216 offset:21760
    s_add_u32 s66, s50, 40960
    s_add_u32 m0, s73, 1024
    s_nop 0
    buffer_load_dwordx4 v253, s[40:43], s66 offen lds
    s_lshl_b32 s67, s62, 7
    s_add_u32 s67, s67, 147456
    v_add_u32 v252, s67, v248
    v_mov_b32 v248, 0x24600
    s_mov_b32 s100, 0
    s_mov_b32 s101, -1
    v_cndmask_b32 v252, v252, v248, s[100:101]
    ds_read_b32 v240, v252 offset:512
    ds_read_b32 v242, v252 offset:576
    v_mfma_f32_32x32x16_bf16 v[128:143], v[208:211], v[8:11], v[128:143]
    ds_read_b64_tr_b16 v[200:201], v216 offset:22528
    ds_read_b64_tr_b16 v[202:203], v216 offset:22784
    s_add_u32 s66, s50, 65536
    s_add_u32 m0, s73, 98304
    s_nop 0
    buffer_load_dwordx4 v253, s[40:43], s66 offen lds
    v_mfma_f32_32x32x16_bf16 v[128:143], v[212:215], v[12:15], v[128:143]
    ds_read_b64_tr_b16 v[204:205], v216 offset:23552
    ds_read_b64_tr_b16 v[206:207], v216 offset:23808
    s_add_u32 s66, s50, 73728
    s_add_u32 m0, s73, 99328
    s_nop 0
    buffer_load_dwordx4 v253, s[40:43], s66 offen lds
    s_waitcnt lgkmcnt(6)
    v_mfma_f32_32x32x16_bf16 v[128:143], v[192:195], v[16:19], v[128:143]
    ds_read_b64_tr_b16 v[208:209], v216 offset:32768
    ds_read_b64_tr_b16 v[210:211], v216 offset:33024
    s_waitcnt lgkmcnt(7)
    v_cvt_pk_bf16_f32 v224, v240, v240
    v_lshlrev_b32 v241, 16, v224
    v_sub_f32 v241, v240, v241
    v_cvt_pk_bf16_f32 v225, v241, 0
    s_nop 1
    v_mfma_f32_32x32x16_bf16 v[160:175], v[224:227], v[228:231], v[160:175]
    v_mfma_f32_32x32x16_bf16 v[128:143], v[196:199], v[20:23], v[128:143]
    ds_read_b64_tr_b16 v[212:213], v216 offset:33792
    ds_read_b64_tr_b16 v[214:215], v216 offset:34048
    s_waitcnt lgkmcnt(8)
    v_cvt_pk_bf16_f32 v224, v242, v242
    v_lshlrev_b32 v243, 16, v224
    v_sub_f32 v243, v242, v243
    v_cvt_pk_bf16_f32 v225, v243, 0
    s_nop 1
    v_mfma_f32_32x32x16_bf16 v[176:191], v[224:227], v[228:231], v[176:191]
    s_waitcnt lgkmcnt(4)
    v_mfma_f32_32x32x16_bf16 v[128:143], v[200:203], v[24:27], v[128:143]
    ds_read_b64_tr_b16 v[192:193], v216 offset:34816
    ds_read_b64_tr_b16 v[194:195], v216 offset:35072
    v_mfma_f32_32x32x16_bf16 v[128:143], v[204:207], v[28:31], v[128:143]
    ds_read_b64_tr_b16 v[196:197], v216 offset:35840
    ds_read_b64_tr_b16 v[198:199], v216 offset:36096
    s_waitcnt lgkmcnt(4)
    v_mfma_f32_32x32x16_bf16 v[128:143], v[208:211], v[32:35], v[128:143]
    ds_read_b64_tr_b16 v[200:201], v216 offset:36864
    ds_read_b64_tr_b16 v[202:203], v216 offset:37120
    v_mul_f32 v232, v160, v160
    v_mul_f32 v233, v161, v161
    v_mul_f32 v234, v162, v162
    v_mul_f32 v235, v163, v163
    v_mul_f32 v236, v164, v164
    v_mul_f32 v237, v165, v165
    v_mul_f32 v238, v166, v166
    v_mfma_f32_32x32x16_bf16 v[128:143], v[212:215], v[36:39], v[128:143]
    ds_read_b64_tr_b16 v[204:205], v216 offset:37888
    ds_read_b64_tr_b16 v[206:207], v216 offset:38144
    v_mul_f32 v239, v167, v167
    v_fma_f32 v232, v232, v221, v220
    v_fma_f32 v233, v233, v221, v220
    v_fma_f32 v234, v234, v221, v220
    v_fma_f32 v235, v235, v221, v220
    v_fma_f32 v236, v236, v221, v220
    v_fma_f32 v237, v237, v221, v220
    s_waitcnt lgkmcnt(4)
    v_mfma_f32_32x32x16_bf16 v[128:143], v[192:195], v[40:43], v[128:143]
    ds_read_b64_tr_b16 v[208:209], v216 offset:38912
    ds_read_b64_tr_b16 v[210:211], v216 offset:39168
    v_fma_f32 v238, v238, v221, v220
    v_fma_f32 v239, v239, v221, v220
    v_mul_f32 v232, v232, v160
    v_mul_f32 v233, v233, v161
    v_mul_f32 v234, v234, v162
    v_mul_f32 v235, v235, v163
    v_mul_f32 v236, v236, v164
    v_mfma_f32_32x32x16_bf16 v[128:143], v[196:199], v[44:47], v[128:143]
    ds_read_b64_tr_b16 v[212:213], v216 offset:39936
    ds_read_b64_tr_b16 v[214:215], v216 offset:40192
    v_mul_f32 v237, v237, v165
    v_mul_f32 v238, v238, v166
    v_mul_f32 v239, v239, v167
    v_exp_f32 v232, v232
    v_exp_f32 v233, v233
    v_exp_f32 v234, v234
    v_exp_f32 v235, v235
    v_exp_f32 v236, v236
    s_waitcnt lgkmcnt(4)
    v_mfma_f32_32x32x16_bf16 v[128:143], v[200:203], v[48:51], v[128:143]
    v_add_u32 v216, 0x10000, v216
    ds_read_b64_tr_b16 v[192:193], v216 offset:0
    ds_read_b64_tr_b16 v[194:195], v216 offset:256
    v_exp_f32 v237, v237
    v_exp_f32 v238, v238
    v_exp_f32 v239, v239
    v_mul_f32 v160, v160, v168
    v_mul_f32 v161, v161, v169
    v_mul_f32 v162, v162, v170
    v_mul_f32 v163, v163, v171
    v_mfma_f32_32x32x16_bf16 v[128:143], v[204:207], v[52:55], v[128:143]
    ds_read_b64_tr_b16 v[196:197], v216 offset:1024
    ds_read_b64_tr_b16 v[198:199], v216 offset:1280
    v_mul_f32 v164, v164, v172
    v_mul_f32 v165, v165, v173
    v_mul_f32 v166, v166, v174
    v_mul_f32 v167, v167, v175
    v_fma_f32 v232, v232, v222, v222
    v_fma_f32 v233, v233, v222, v222
    v_fma_f32 v234, v234, v222, v222
    s_waitcnt lgkmcnt(4)
    v_mfma_f32_32x32x16_bf16 v[128:143], v[208:211], v[56:59], v[128:143]
    ds_read_b64_tr_b16 v[200:201], v216 offset:2048
    ds_read_b64_tr_b16 v[202:203], v216 offset:2304
    v_fma_f32 v235, v235, v222, v222
    v_fma_f32 v236, v236, v222, v222
    v_fma_f32 v237, v237, v222, v222
    v_fma_f32 v238, v238, v222, v222
    v_fma_f32 v239, v239, v222, v222
    v_rcp_f32 v232, v232
    v_rcp_f32 v233, v233
    v_mfma_f32_32x32x16_bf16 v[128:143], v[212:215], v[60:63], v[128:143]
    ds_read_b64_tr_b16 v[204:205], v216 offset:3072
    ds_read_b64_tr_b16 v[206:207], v216 offset:3328
    v_rcp_f32 v234, v234
    v_rcp_f32 v235, v235
    v_rcp_f32 v236, v236
    v_rcp_f32 v237, v237
    v_rcp_f32 v238, v238
    v_rcp_f32 v239, v239
    v_mul_f32 v160, v160, v232
    v_mul_f32 v161, v161, v233
    s_waitcnt vmcnt(7)
    s_barrier
    s_waitcnt vmcnt(4)
    s_barrier
    s_cmp_lg_u32 s60, 0
    s_cbranch_scc1 L_cnt10
    s_add_u32 s66, s65, 32
    s_lshl_b32 s66, s66, 5
    s_add_u32 s66, s66, s63
    s_lshl_b32 s66, s66, 2
    v_mov_b32 v250, s66
    v_mov_b32 v251, 1
    s_mov_b64 s[76:77], exec
    s_mov_b64 exec, 1
    buffer_store_dword v251, v250, s[36:39], 0 offen sc1
    s_mov_b64 exec, s[76:77]
    s_nop 1
L_cnt10:
    s_waitcnt lgkmcnt(4)
    v_mfma_f32_32x32x16_bf16 v[128:143], v[192:195], v[64:67], v[128:143]
    ds_read_b64_tr_b16 v[208:209], v216 offset:4096
    ds_read_b64_tr_b16 v[210:211], v216 offset:4352
    s_add_u32 s66, s50, 98304
    s_add_u32 m0, s73, 16384
    s_nop 0
    buffer_load_dwordx4 v253, s[40:43], s66 offen lds
    v_mul_f32 v162, v162, v234
    v_mul_f32 v163, v163, v235
    v_mul_f32 v164, v164, v236
    v_mul_f32 v165, v165, v237
    v_mul_f32 v166, v166, v238
    v_mul_f32 v167, v167, v239
    v_cvt_pk_bf16_f32 v168, v160, v161
    v_mfma_f32_32x32x16_bf16 v[128:143], v[196:199], v[68:71], v[128:143]
    ds_read_b64_tr_b16 v[212:213], v216 offset:5120
    ds_read_b64_tr_b16 v[214:215], v216 offset:5376
    s_add_u32 s66, s50, 106496
    s_add_u32 m0, s73, 17408
    s_nop 0
    buffer_load_dwordx4 v253, s[40:43], s66 offen lds
    v_cvt_pk_bf16_f32 v169, v162, v163
    v_cvt_pk_bf16_f32 v170, v164, v165
    v_cvt_pk_bf16_f32 v171, v166, v167
    s_add_u32 s67, s3, 65536
    buffer_store_dwordx4 v[168:171], v254, s[28:31], s67 offen sc1
    v_mul_f32 v232, v176, v176
    v_mul_f32 v233, v177, v177
    v_mul_f32 v234, v178, v178
    s_waitcnt lgkmcnt(4)
    v_mfma_f32_32x32x16_bf16 v[128:143], v[200:203], v[72:75], v[128:143]
    ds_read_b64_tr_b16 v[192:193], v216 offset:6144
    ds_read_b64_tr_b16 v[194:195], v216 offset:6400
    s_add_u32 s66, s50, 131072
    s_add_u32 m0, s73, 32768
    s_nop 0
    buffer_load_dwordx4 v253, s[40:43], s66 offen lds
    v_mul_f32 v235, v179, v179
    v_mul_f32 v236, v180, v180
    v_mul_f32 v237, v181, v181
    v_mul_f32 v238, v182, v182
    v_mul_f32 v239, v183, v183
    v_fma_f32 v232, v232, v221, v220
    v_fma_f32 v233, v233, v221, v220
    v_mfma_f32_32x32x16_bf16 v[128:143], v[204:207], v[76:79], v[128:143]
    ds_read_b64_tr_b16 v[196:197], v216 offset:7168
    ds_read_b64_tr_b16 v[198:199], v216 offset:7424
    s_add_u32 s66, s50, 139264
    s_add_u32 m0, s73, 33792
    s_nop 0
    buffer_load_dwordx4 v253, s[40:43], s66 offen lds
    v_fma_f32 v234, v234, v221, v220
    v_fma_f32 v235, v235, v221, v220
    v_fma_f32 v236, v236, v221, v220
    v_fma_f32 v237, v237, v221, v220
    v_fma_f32 v238, v238, v221, v220
    v_fma_f32 v239, v239, v221, v220
    v_mul_f32 v232, v232, v176
    v_mul_f32 v233, v233, v177
    s_waitcnt lgkmcnt(4)
    v_mfma_f32_32x32x16_bf16 v[128:143], v[208:211], v[80:83], v[128:143]
    v_add_u32 v216, 0xffff0000, v216
    ds_read_b64_tr_b16 v[200:201], v216 offset:49152
    ds_read_b64_tr_b16 v[202:203], v216 offset:49408
    v_mul_f32 v234, v234, v178
    v_mul_f32 v235, v235, v179
    v_mul_f32 v236, v236, v180
    v_mul_f32 v237, v237, v181
    v_mul_f32 v238, v238, v182
    v_mul_f32 v239, v239, v183
    v_exp_f32 v232, v232
    v_mfma_f32_32x32x16_bf16 v[128:143], v[212:215], v[84:87], v[128:143]
    ds_read_b64_tr_b16 v[204:205], v216 offset:50176
    ds_read_b64_tr_b16 v[206:207], v216 offset:50432
    v_exp_f32 v233, v233
    v_exp_f32 v234, v234
    v_exp_f32 v235, v235
    v_exp_f32 v236, v236
    v_exp_f32 v237, v237
    v_exp_f32 v238, v238
    v_exp_f32 v239, v239
    s_waitcnt lgkmcnt(4)
    v_mfma_f32_32x32x16_bf16 v[128:143], v[192:195], v[88:91], v[128:143]
    ds_read_b64_tr_b16 v[208:209], v216 offset:51200
    ds_read_b64_tr_b16 v[210:211], v216 offset:51456
    v_mul_f32 v176, v176, v184
    v_mul_f32 v177, v177, v185
    v_mul_f32 v178, v178, v186
    v_mul_f32 v179, v179, v187
    v_mul_f32 v180, v180, v188
    v_mul_f32 v181, v181, v189
    v_mul_f32 v182, v182, v190
    v_mfma_f32_32x32x16_bf16 v[128:143], v[196:199], v[92:95], v[128:143]
    ds_read_b64_tr_b16 v[212:213], v216 offset:52224
    ds_read_b64_tr_b16 v[214:215], v216 offset:52480
    v_mul_f32 v183, v183, v191
    v_fma_f32 v232, v232, v222, v222
    v_fma_f32 v233, v233, v222, v222
    v_fma_f32 v234, v234, v222, v222
    v_fma_f32 v235, v235, v222, v222
    v_fma_f32 v236, v236, v222, v222
    v_fma_f32 v237, v237, v222, v222
    v_fma_f32 v238, v238, v222, v222
    s_waitcnt lgkmcnt(4)
    v_mfma_f32_32x32x16_bf16 v[128:143], v[200:203], v[96:99], v[128:143]
    ds_read_b64_tr_b16 v[192:193], v216 offset:53248
    ds_read_b64_tr_b16 v[194:195], v216 offset:53504
    v_fma_f32 v239, v239, v222, v222
    v_rcp_f32 v232, v232
    v_rcp_f32 v233, v233
    v_rcp_f32 v234, v234
    v_rcp_f32 v235, v235
    v_rcp_f32 v236, v236
    v_rcp_f32 v237, v237
    v_mfma_f32_32x32x16_bf16 v[128:143], v[204:207], v[100:103], v[128:143]
    ds_read_b64_tr_b16 v[196:197], v216 offset:54272
    ds_read_b64_tr_b16 v[198:199], v216 offset:54528
    v_rcp_f32 v238, v238
    v_rcp_f32 v239, v239
    v_mul_f32 v176, v176, v232
    v_mul_f32 v177, v177, v233
    v_mul_f32 v178, v178, v234
    v_mul_f32 v179, v179, v235
    v_mul_f32 v180, v180, v236
    s_waitcnt lgkmcnt(4)
    v_mfma_f32_32x32x16_bf16 v[128:143], v[208:211], v[104:107], v[128:143]
    ds_read_b64_tr_b16 v[200:201], v216 offset:55296
    ds_read_b64_tr_b16 v[202:203], v216 offset:55552
    v_mul_f32 v181, v181, v237
    v_mul_f32 v182, v182, v238
    v_mul_f32 v183, v183, v239
    v_cvt_pk_bf16_f32 v184, v176, v177
    v_mfma_f32_32x32x16_bf16 v[128:143], v[212:215], v[108:111], v[128:143]
    ds_read_b64_tr_b16 v[204:205], v216 offset:56320
    ds_read_b64_tr_b16 v[206:207], v216 offset:56576
    v_cvt_pk_bf16_f32 v185, v178, v179
    v_cvt_pk_bf16_f32 v186, v180, v181
    v_cvt_pk_bf16_f32 v187, v182, v183
    s_add_u32 s67, s3, 66560
    buffer_store_dwordx4 v[184:187], v254, s[28:31], s67 offen sc1
    s_waitcnt lgkmcnt(4)
    v_mfma_f32_32x32x16_bf16 v[128:143], v[192:195], v[112:115], v[128:143]
    v_mfma_f32_32x32x16_bf16 v[128:143], v[196:199], v[116:119], v[128:143]
    s_waitcnt lgkmcnt(0)
    v_mfma_f32_32x32x16_bf16 v[128:143], v[200:203], v[120:123], v[128:143]
    v_mfma_f32_32x32x16_bf16 v[128:143], v[204:207], v[124:127], v[128:143]
    s_lshr_b32 s3, s65, 1
    s_lshl_b32 s3, s3, 2
    s_and_b32 s67, s65, 1
    s_lshl_b32 s67, s67, 1
    s_add_u32 s3, s3, s67
    s_add_u32 s3, s3, s62
    s_lshl_b32 s3, s3, 10
    v_bfe_u32 v248, v255, 4, 1
    v_lshlrev_b32 v248, 7, v248
    v_and_b32 v249, 15, v255
    v_lshl_add_u32 v248, v249, 2, v248
    s_lshl_b32 s67, s62, 6
    s_add_u32 s67, s67, 147456
    v_add_u32 v252, s67, v248
    v_mov_b32 v248, 0x24600
    s_mov_b32 s100, 0
    s_mov_b32 s101, -1
    v_cndmask_b32 v252, v252, v248, s[100:101]
    ds_read_b32 v240, v252 offset:1024
    s_waitcnt lgkmcnt(0)
    v_cvt_pk_bf16_f32 v224, v240, v240
    v_lshlrev_b32 v241, 16, v224
    v_sub_f32 v241, v240, v241
    v_cvt_pk_bf16_f32 v225, v241, 0
    s_nop 1
    v_mfma_f32_32x32x16_bf16 v[128:143], v[224:227], v[228:231], v[128:143]
    s_nop 11
    v_mul_f32 v232, v128, v128
    v_mul_f32 v233, v129, v129
    v_mul_f32 v234, v130, v130
    v_mul_f32 v235, v131, v131
    v_mul_f32 v236, v132, v132
    v_mul_f32 v237, v133, v133
    v_mul_f32 v238, v134, v134
    v_mul_f32 v239, v135, v135
    v_fma_f32 v232, v232, v221, v220
    v_fma_f32 v233, v233, v221, v220
    v_fma_f32 v234, v234, v221, v220
    v_fma_f32 v235, v235, v221, v220
    v_fma_f32 v236, v236, v221, v220
    v_fma_f32 v237, v237, v221, v220
    v_fma_f32 v238, v238, v221, v220
    v_fma_f32 v239, v239, v221, v220
    v_mul_f32 v232, v232, v128
    v_mul_f32 v233, v233, v129
    v_mul_f32 v234, v234, v130
    v_mul_f32 v235, v235, v131
    v_mul_f32 v236, v236, v132
    v_mul_f32 v237, v237, v133
    v_mul_f32 v238, v238, v134
    v_mul_f32 v239, v239, v135
    v_exp_f32 v232, v232
    v_exp_f32 v233, v233
    v_exp_f32 v234, v234
    v_exp_f32 v235, v235
    v_exp_f32 v236, v236
    v_exp_f32 v237, v237
    v_exp_f32 v238, v238
    v_exp_f32 v239, v239
    v_mul_f32 v128, v128, v136
    v_mul_f32 v129, v129, v137
    v_mul_f32 v130, v130, v138
    v_mul_f32 v131, v131, v139
    v_mul_f32 v132, v132, v140
    v_mul_f32 v133, v133, v141
    v_mul_f32 v134, v134, v142
    v_mul_f32 v135, v135, v143
    v_fma_f32 v232, v232, v222, v222
    v_fma_f32 v233, v233, v222, v222
    v_fma_f32 v234, v234, v222, v222
    v_fma_f32 v235, v235, v222, v222
    v_fma_f32 v236, v236, v222, v222
    v_fma_f32 v237, v237, v222, v222
    v_fma_f32 v238, v238, v222, v222
    v_fma_f32 v239, v239, v222, v222
    v_rcp_f32 v232, v232
    v_rcp_f32 v233, v233
    v_rcp_f32 v234, v234
    v_rcp_f32 v235, v235
    v_rcp_f32 v236, v236
    v_rcp_f32 v237, v237
    v_rcp_f32 v238, v238
    v_rcp_f32 v239, v239
    v_mul_f32 v128, v128, v232
    v_mul_f32 v129, v129, v233
    v_mul_f32 v130, v130, v234
    v_mul_f32 v131, v131, v235
    v_mul_f32 v132, v132, v236
    v_mul_f32 v133, v133, v237
    v_mul_f32 v134, v134, v238
    v_mul_f32 v135, v135, v239
    v_cvt_pk_bf16_f32 v136, v128, v129
    v_cvt_pk_bf16_f32 v137, v130, v131
    v_cvt_pk_bf16_f32 v138, v132, v133
    v_cvt_pk_bf16_f32 v139, v134, v135
    s_add_u32 s67, s3, 98304
    buffer_store_dwordx4 v[136:139], v254, s[28:31], s67 offen sc1
    s_waitcnt vmcnt(0)
    s_barrier
    s_cmp_lg_u32 s60, 0
    s_cbranch_scc1 L_cnt11
    s_add_u32 s66, s63, 40
    s_lshl_b32 s66, s66, 5
    s_add_u32 s66, s66, s64
    s_lshl_b32 s66, s66, 2
    v_mov_b32 v250, s66
    v_mov_b32 v251, 1
    s_mov_b64 s[76:77], exec
    s_mov_b64 exec, 1
    buffer_store_dword v251, v250, s[36:39], 0 offen sc1
    s_mov_b64 exec, s[76:77]
    s_nop 1
L_cnt11:
    s_add_u32 s66, s50, 163840
    s_add_u32 m0, s73, 49152
    s_nop 0
    buffer_load_dwordx4 v253, s[40:43], s66 offen lds
    s_add_u32 s66, s50, 172032
    s_add_u32 m0, s73, 50176
    s_nop 0
    buffer_load_dwordx4 v253, s[40:43], s66 offen lds
    s_add_u32 s66, s50, 196608
    s_add_u32 m0, s73, 65536
    s_nop 0
    buffer_load_dwordx4 v253, s[40:43], s66 offen lds
    s_add_u32 s66, s50, 204800
    s_add_u32 m0, s73, 66560
    s_nop 0
    buffer_load_dwordx4 v253, s[40:43], s66 offen lds
    s_add_u32 s66, s50, 229376
    s_add_u32 m0, s73, 114688
    s_nop 0
    buffer_load_dwordx4 v253, s[40:43], s66 offen lds
    s_add_u32 s66, s50, 237568
    s_add_u32 m0, s73, 115712
    s_nop 0
    buffer_load_dwordx4 v253, s[40:43], s66 offen lds
    s_add_u32 s66, s50, 262144
    s_add_u32 m0, s73, 131072
    s_nop 0
    buffer_load_dwordx4 v253, s[40:43], s66 offen lds
    s_add_u32 s66, s50, 270336
    s_add_u32 m0, s73, 132096
    s_nop 0
    buffer_load_dwordx4 v253, s[40:43], s66 offen lds
    v_and_b32 v0, 63, v255
    v_lshrrev_b32 v1, 5, v0
    v_lshlrev_b32 v1, 2, v1
    v_bfe_u32 v2, v0, 2, 2
    v_add_u32 v1, v1, v2
    v_lshlrev_b32 v236, 7, v1
    v_bfe_u32 v1, v0, 4, 1
    v_lshlrev_b32 v1, 1, v1
    v_bfe_u32 v2, v0, 1, 1
    v_add_u32 v1, v1, v2
    v_bfe_u32 v2, v0, 3, 1
    v_lshlrev_b32 v2, 2, v2
    v_xor_b32 v1, v1, v2
    v_lshl_add_u32 v236, v1, 4, v236
    v_and_b32 v1, 1, v0
    v_lshl_add_u32 v236, v1, 3, v236
    s_lshl_b32 s66, s48, 12
    v_add_u32 v236, s66, v236
    v_xor_b32 v237, 64, v236
    s_mov_b32 s16, s4
    s_mov_b32 s17, s5
    s_mov_b32 s18, 2097152
    s_mov_b32 s19, 0x20000
    s_mov_b32 s20, s10
    s_mov_b32 s21, s11
    s_mov_b32 s22, 2097152
    s_mov_b32 s23, 0x20000
    v_lshrrev_b32 v1, 3, v255
    v_lshlrev_b32 v238, 10, v1
    v_and_b32 v1, 7, v255
    v_lshl_add_u32 v238, v1, 4, v238
    s_lshl_b32 s66, s74, 16
    s_lshl_b32 s67, s75, 7
    s_add_u32 s66, s66, s67
    v_add_u32 v238, s66, v238
    buffer_load_dwordx4 v[232:235], v238, s[16:19], 0 offen
    s_mov_b32 s24, s28
    s_mov_b32 s25, s29
    s_mov_b32 s26, s30
    s_mov_b32 s27, s31
    s_lshl_b32 s66, s74, 1
    s_add_u32 s66, s66, s49
    s_mul_i32 s66, s66, 147456
    s_add_u32 s28, s58, s66
    s_addc_u32 s29, s59, 0
    s_mov_b32 s30, 147456
    s_mov_b32 s31, 0x20000
    s_mul_i32 s14, s48, 28672
    s_lshl_b32 s15, s48, 13
    s_add_u32 s15, s15, 86016
    s_lshr_b32 s68, s74, 1
    s_add_u32 s66, s68, 40
    s_lshl_b32 s66, s66, 7
    v_and_b32 v239, 15, v255
    v_lshlrev_b32 v239, 2, v239
    v_add_u32 v239, s66, v239
    s_mov_b32 s78, 0x40000
L_spin12:
    buffer_load_dword v252, v239, s[36:39], 0 offen sc1
    s_waitcnt vmcnt(0)
    v_cmp_ne_u32 vcc, 0, v252
    s_nop 3
    s_and_b32 s66, vcc_lo, 0xffff
    s_cmp_eq_u32 s66, 0xffff
    s_cbranch_scc1 L_spun12
    s_sleep 8
    s_sub_u32 s78, s78, 1
    s_cbranch_scc0 L_spin12
L_spun12:
    s_add_u32 s67, s14, 0
    buffer_load_dwordx4 v[0:3], v254, s[28:31], s67 offen offset:0 sc1
    buffer_load_dwordx4 v[4:7], v254, s[28:31], s67 offen offset:1024 sc1
    buffer_load_dwordx4 v[8:11], v254, s[28:31], s67 offen offset:2048 sc1
    buffer_load_dwordx4 v[12:15], v254, s[28:31], s67 offen offset:3072 sc1
    s_add_u32 s67, s14, 4096
    buffer_load_dwordx4 v[16:19], v254, s[28:31], s67 offen offset:0 sc1
    buffer_load_dwordx4 v[20:23], v254, s[28:31], s67 offen offset:1024 sc1
    buffer_load_dwordx4 v[24:27], v254, s[28:31], s67 offen offset:2048 sc1
    buffer_load_dwordx4 v[28:31], v254, s[28:31], s67 offen offset:3072 sc1
    s_barrier
    v_add_u32 v236, 0x10000, v236
    v_add_u32 v237, 0x10000, v237
    ds_read_b64_tr_b16 v[208:209], v236 offset:16384
    ds_read_b64_tr_b16 v[210:211], v236 offset:17408
    ds_read_b64_tr_b16 v[212:213], v237 offset:16384
    ds_read_b64_tr_b16 v[214:215], v237 offset:17408
    ds_read_b64_tr_b16 v[216:217], v236 offset:18432
    ds_read_b64_tr_b16 v[218:219], v236 offset:19456
    ds_read_b64_tr_b16 v[220:221], v237 offset:18432
    ds_read_b64_tr_b16 v[222:223], v237 offset:19456
    s_barrier
    s_waitcnt lgkmcnt(4)
    s_waitcnt vmcnt(7)
    v_mfma_f32_32x32x16_bf16 v[144:159], v[208:211], v[0:3], 0
    v_add_u32 v236, 0xffff0000, v236
    v_add_u32 v237, 0xffff0000, v237
    ds_read_b64_tr_b16 v[224:225], v236 offset:0
    ds_read_b64_tr_b16 v[226:227], v236 offset:1024
    v_mfma_f32_32x32x16_bf16 v[160:175], v[212:215], v[0:3], 0
    ds_read_b64_tr_b16 v[228:229], v237 offset:0
    ds_read_b64_tr_b16 v[230:231], v237 offset:1024
    s_add_u32 s67, s14, 8192
    buffer_load_dwordx4 v[32:35], v254, s[28:31], s67 offen offset:0 sc1
    s_waitcnt lgkmcnt(4)
    s_waitcnt vmcnt(7)
    v_mfma_f32_32x32x16_bf16 v[144:159], v[216:219], v[4:7], v[144:159]
    ds_read_b64_tr_b16 v[208:209], v236 offset:2048
    ds_read_b64_tr_b16 v[210:211], v236 offset:3072
    v_mfma_f32_32x32x16_bf16 v[160:175], v[220:223], v[4:7], v[160:175]
    ds_read_b64_tr_b16 v[212:213], v237 offset:2048
    ds_read_b64_tr_b16 v[214:215], v237 offset:3072
    s_add_u32 s67, s14, 8192
    buffer_load_dwordx4 v[36:39], v254, s[28:31], s67 offen offset:1024 sc1
    s_waitcnt lgkmcnt(4)
    s_waitcnt vmcnt(7)
    v_mfma_f32_32x32x16_bf16 v[144:159], v[224:227], v[8:11], v[144:159]
    v_add_u32 v236, 0x10000, v236
    v_add_u32 v237, 0x10000, v237
    ds_read_b64_tr_b16 v[216:217], v236 offset:32768
    ds_read_b64_tr_b16 v[218:219], v236 offset:33792
    v_mfma_f32_32x32x16_bf16 v[160:175], v[228:231], v[8:11], v[160:175]
    ds_read_b64_tr_b16 v[220:221], v237 offset:32768
    ds_read_b64_tr_b16 v[222:223], v237 offset:33792
    s_add_u32 s67, s14, 8192
    buffer_load_dwordx4 v[40:43], v254, s[28:31], s67 offen offset:2048 sc1
    s_waitcnt lgkmcnt(4)
    s_waitcnt vmcnt(7)
    v_mfma_f32_32x32x16_bf16 v[144:159], v[208:211], v[12:15], v[144:159]
    ds_read_b64_tr_b16 v[224:225], v236 offset:34816
    ds_read_b64_tr_b16 v[226:227], v236 offset:35840
    v_mfma_f32_32x32x16_bf16 v[160:175], v[212:215], v[12:15], v[160:175]
    ds_read_b64_tr_b16 v[228:229], v237 offset:34816
    ds_read_b64_tr_b16 v[230:231], v237 offset:35840
    s_add_u32 s67, s14, 8192
    buffer_load_dwordx4 v[44:47], v254, s[28:31], s67 offen offset:3072 sc1
    s_barrier
    s_waitcnt lgkmcnt(4)
    s_waitcnt vmcnt(7)
    v_mfma_f32_32x32x16_bf16 v[144:159], v[216:219], v[16:19], v[144:159]
    v_add_u32 v236, 0xffff0000, v236
    v_add_u32 v237, 0xffff0000, v237
    ds_read_b64_tr_b16 v[208:209], v236 offset:16384
    ds_read_b64_tr_b16 v[210:211], v236 offset:17408
    s_add_u32 s66, s50, 294912
    s_add_u32 m0, s73, 0
    s_nop 0
    buffer_load_dwordx4 v253, s[40:43], s66 offen lds
    v_mfma_f32_32x32x16_bf16 v[160:175], v[220:223], v[16:19], v[160:175]
    ds_read_b64_tr_b16 v[212:213], v237 offset:16384
    ds_read_b64_tr_b16 v[214:215], v237 offset:17408
    s_add_u32 s66, s50, 303104
    s_add_u32 m0, s73, 1024
    s_nop 0
    buffer_load_dwordx4 v253, s[40:43], s66 offen lds
    s_add_u32 s67, s14, 12288
    buffer_load_dwordx4 v[48:51], v254, s[28:31], s67 offen offset:0 sc1
    s_waitcnt lgkmcnt(4)
    s_waitcnt vmcnt(9)
    v_mfma_f32_32x32x16_bf16 v[144:159], v[224:227], v[20:23], v[144:159]
    ds_read_b64_tr_b16 v[216:217], v236 offset:18432
    ds_read_b64_tr_b16 v[218:219], v236 offset:19456
    s_add_u32 s66, s50, 327680
    s_add_u32 m0, s73, 81920
    s_nop 0
    buffer_load_dwordx4 v253, s[40:43], s66 offen lds
    v_mfma_f32_32x32x16_bf16 v[160:175], v[228:231], v[20:23], v[160:175]
    ds_read_b64_tr_b16 v[220:221], v237 offset:18432
    ds_read_b64_tr_b16 v[222:223], v237 offset:19456
    s_add_u32 s66, s50, 335872
    s_add_u32 m0, s73, 82944
    s_nop 0
    buffer_load_dwordx4 v253, s[40:43], s66 offen lds
    s_add_u32 s67, s14, 12288
    buffer_load_dwordx4 v[52:55], v254, s[28:31], s67 offen offset:1024 sc1
    s_waitcnt lgkmcnt(4)
    s_waitcnt vmcnt(11)
    v_mfma_f32_32x32x16_bf16 v[144:159], v[208:211], v[24:27], v[144:159]
    ds_read_b64_tr_b16 v[224:225], v236 offset:32768
    ds_read_b64_tr_b16 v[226:227], v236 offset:33792
    v_mfma_f32_32x32x16_bf16 v[160:175], v[212:215], v[24:27], v[160:175]
    ds_read_b64_tr_b16 v[228:229], v237 offset:32768
    ds_read_b64_tr_b16 v[230:231], v237 offset:33792
    s_add_u32 s67, s14, 12288
    buffer_load_dwordx4 v[56:59], v254, s[28:31], s67 offen offset:2048 sc1
    s_waitcnt lgkmcnt(4)
    s_waitcnt vmcnt(11)
    v_mfma_f32_32x32x16_bf16 v[144:159], v[216:219], v[28:31], v[144:159]
    ds_read_b64_tr_b16 v[208:209], v236 offset:34816
    ds_read_b64_tr_b16 v[210:211], v236 offset:35840
    v_mfma_f32_32x32x16_bf16 v[160:175], v[220:223], v[28:31], v[160:175]
    ds_read_b64_tr_b16 v[212:213], v237 offset:34816
    ds_read_b64_tr_b16 v[214:215], v237 offset:35840
    s_add_u32 s67, s14, 12288
    buffer_load_dwordx4 v[60:63], v254, s[28:31], s67 offen offset:3072 sc1
    s_barrier
    s_waitcnt lgkmcnt(4)
    s_waitcnt vmcnt(11)
    v_mfma_f32_32x32x16_bf16 v[144:159], v[224:227], v[32:35], v[144:159]
    ds_read_b64_tr_b16 v[216:217], v236 offset:49152
    ds_read_b64_tr_b16 v[218:219], v236 offset:50176
    s_add_u32 s66, s50, 360448
    s_add_u32 m0, s73, 16384
    s_nop 0
    buffer_load_dwordx4 v253, s[40:43], s66 offen lds
    v_mfma_f32_32x32x16_bf16 v[160:175], v[228:231], v[32:35], v[160:175]
    ds_read_b64_tr_b16 v[220:221], v237 offset:49152
    ds_read_b64_tr_b16 v[222:223], v237 offset:50176
    s_add_u32 s66, s50, 368640
    s_add_u32 m0, s73, 17408
    s_nop 0
    buffer_load_dwordx4 v253, s[40:43], s66 offen lds
    s_add_u32 s67, s14, 16384
    buffer_load_dwordx4 v[64:67], v254, s[28:31], s67 offen offset:0 sc1
    s_waitcnt lgkmcnt(4)
    s_waitcnt vmcnt(13)
    v_mfma_f32_32x32x16_bf16 v[144:159], v[208:211], v[36:39], v[144:159]
    ds_read_b64_tr_b16 v[224:225], v236 offset:51200
    ds_read_b64_tr_b16 v[226:227], v236 offset:52224
    s_add_u32 s66, s50, 393216
    s_add_u32 m0, s73, 98304
    s_nop 0
    buffer_load_dwordx4 v253, s[40:43], s66 offen lds
    v_mfma_f32_32x32x16_bf16 v[160:175], v[212:215], v[36:39], v[160:175]
    ds_read_b64_tr_b16 v[228:229], v237 offset:51200
    ds_read_b64_tr_b16 v[230:231], v237 offset:52224
    s_add_u32 s66, s50, 401408
    s_add_u32 m0, s73, 99328
    s_nop 0
    buffer_load_dwordx4 v253, s[40:43], s66 offen lds
    s_add_u32 s67, s14, 16384
    buffer_load_dwordx4 v[68:71], v254, s[28:31], s67 offen offset:1024 sc1
    s_waitcnt lgkmcnt(4)
    s_waitcnt vmcnt(15)
    v_mfma_f32_32x32x16_bf16 v[144:159], v[216:219], v[40:43], v[144:159]
    v_add_u32 v236, 0x10000, v236
    v_add_u32 v237, 0x10000, v237
    ds_read_b64_tr_b16 v[208:209], v236 offset:0
    ds_read_b64_tr_b16 v[210:211], v236 offset:1024
    v_mfma_f32_32x32x16_bf16 v[160:175], v[220:223], v[40:43], v[160:175]
    ds_read_b64_tr_b16 v[212:213], v237 offset:0
    ds_read_b64_tr_b16 v[214:215], v237 offset:1024
    s_add_u32 s67, s14, 16384
    buffer_load_dwordx4 v[72:75], v254, s[28:31], s67 offen offset:2048 sc1
    s_waitcnt lgkmcnt(4)
    s_waitcnt vmcnt(15)
    v_mfma_f32_32x32x16_bf16 v[144:159], v[224:227], v[44:47], v[144:159]
    ds_read_b64_tr_b16 v[216:217], v236 offset:2048
    ds_read_b64_tr_b16 v[218:219], v236 offset:3072
    v_mfma_f32_32x32x16_bf16 v[160:175], v[228:231], v[44:47], v[160:175]
    ds_read_b64_tr_b16 v[220:221], v237 offset:2048
    ds_read_b64_tr_b16 v[222:223], v237 offset:3072
    s_add_u32 s67, s14, 16384
    buffer_load_dwordx4 v[76:79], v254, s[28:31], s67 offen offset:3072 sc1
    s_barrier
    s_waitcnt lgkmcnt(4)
    s_waitcnt vmcnt(13)
    v_mfma_f32_32x32x16_bf16 v[144:159], v[208:211], v[48:51], v[144:159]
    ds_read_b64_tr_b16 v[224:225], v236 offset:49152
    ds_read_b64_tr_b16 v[226:227], v236 offset:50176
    v_mfma_f32_32x32x16_bf16 v[160:175], v[212:215], v[48:51], v[160:175]
    ds_read_b64_tr_b16 v[228:229], v237 offset:49152
    ds_read_b64_tr_b16 v[230:231], v237 offset:50176
    s_add_u32 s67, s14, 20480
    buffer_load_dwordx4 v[80:83], v254, s[28:31], s67 offen offset:0 sc1
    s_waitcnt lgkmcnt(4)
    s_waitcnt vmcnt(11)
    v_mfma_f32_32x32x16_bf16 v[144:159], v[216:219], v[52:55], v[144:159]
    ds_read_b64_tr_b16 v[208:209], v236 offset:51200
    ds_read_b64_tr_b16 v[210:211], v236 offset:52224
    v_mfma_f32_32x32x16_bf16 v[160:175], v[220:223], v[52:55], v[160:175]
    ds_read_b64_tr_b16 v[212:213], v237 offset:51200
    ds_read_b64_tr_b16 v[214:215], v237 offset:52224
    s_add_u32 s67, s14, 20480
    buffer_load_dwordx4 v[84:87], v254, s[28:31], s67 offen offset:1024 sc1
    s_waitcnt lgkmcnt(4)
    s_waitcnt vmcnt(11)
    v_mfma_f32_32x32x16_bf16 v[144:159], v[224:227], v[56:59], v[144:159]
    v_add_u32 v236, 0x10000, v236
    v_add_u32 v237, 0x10000, v237
    ds_read_b64_tr_b16 v[216:217], v236 offset:0
    ds_read_b64_tr_b16 v[218:219], v236 offset:1024
    v_mfma_f32_32x32x16_bf16 v[160:175], v[228:231], v[56:59], v[160:175]
    ds_read_b64_tr_b16 v[220:221], v237 offset:0
    ds_read_b64_tr_b16 v[222:223], v237 offset:1024
    s_add_u32 s67, s14, 20480
    buffer_load_dwordx4 v[88:91], v254, s[28:31], s67 offen offset:2048 sc1
    s_lshr_b32 s68, s74, 1
    s_add_u32 s66, s68, 56
    s_lshl_b32 s66, s66, 7
    v_and_b32 v239, 15, v255
    v_lshlrev_b32 v239, 2, v239
    v_add_u32 v239, s66, v239
    buffer_load_dword v248, v239, s[36:39], 0 offen sc1
    s_waitcnt lgkmcnt(4)
    s_waitcnt vmcnt(12)
    v_mfma_f32_32x32x16_bf16 v[144:159], v[208:211], v[60:63], v[144:159]
    ds_read_b64_tr_b16 v[224:225], v236 offset:2048
    ds_read_b64_tr_b16 v[226:227], v236 offset:3072
    v_mfma_f32_32x32x16_bf16 v[160:175], v[212:215], v[60:63], v[160:175]
    ds_read_b64_tr_b16 v[228:229], v237 offset:2048
    ds_read_b64_tr_b16 v[230:231], v237 offset:3072
    s_add_u32 s67, s14, 20480
    buffer_load_dwordx4 v[92:95], v254, s[28:31], s67 offen offset:3072 sc1
    s_barrier
    s_waitcnt lgkmcnt(4)
    s_waitcnt vmcnt(10)
    v_mfma_f32_32x32x16_bf16 v[144:159], v[216:219], v[64:67], v[144:159]
    v_add_u32 v236, 0xfffe0000, v236
    v_add_u32 v237, 0xfffe0000, v237
    ds_read_b64_tr_b16 v[208:209], v236 offset:0
    ds_read_b64_tr_b16 v[210:211], v236 offset:1024
    s_add_u32 s66, s50, 425984
    s_add_u32 m0, s73, 65536
    s_nop 0
    buffer_load_dwordx4 v253, s[40:43], s66 offen lds
    v_mfma_f32_32x32x16_bf16 v[160:175], v[220:223], v[64:67], v[160:175]
    ds_read_b64_tr_b16 v[212:213], v237 offset:0
    ds_read_b64_tr_b16 v[214:215], v237 offset:1024
    s_add_u32 s66, s50, 434176
    s_add_u32 m0, s73, 66560
    s_nop 0
    buffer_load_dwordx4 v253, s[40:43], s66 offen lds
    s_add_u32 s67, s14, 24576
    buffer_load_dwordx4 v[96:99], v254, s[28:31], s67 offen offset:0 sc1
    s_waitcnt lgkmcnt(4)
    s_waitcnt vmcnt(10)
    v_mfma_f32_32x32x16_bf16 v[144:159], v[224:227], v[68:71], v[144:159]
    ds_read_b64_tr_b16 v[216:217], v236 offset:2048
    ds_read_b64_tr_b16 v[218:219], v236 offset:3072
    s_add_u32 s66, s51, 0
    s_add_u32 m0, s73, 114688
    s_nop 0
    buffer_load_dwordx4 v253, s[44:47], s66 offen lds
    v_mfma_f32_32x32x16_bf16 v[160:175], v[228:231], v[68:71], v[160:175]
    ds_read_b64_tr_b16 v[220:221], v237 offset:2048
    ds_read_b64_tr_b16 v[222:223], v237 offset:3072
    s_add_u32 s66, s51, 8192
    s_add_u32 m0, s73, 115712
    s_nop 0
    buffer_load_dwordx4 v253, s[44:47], s66 offen lds
    s_add_u32 s67, s14, 24576
    buffer_load_dwordx4 v[100:103], v254, s[28:31], s67 offen offset:1024 sc1
    s_waitcnt lgkmcnt(4)
    s_waitcnt vmcnt(12)
    v_mfma_f32_32x32x16_bf16 v[144:159], v[208:211], v[72:75], v[144:159]
    v_add_u32 v236, 0x10000, v236
    v_add_u32 v237, 0x10000, v237
    ds_read_b64_tr_b16 v[224:225], v236 offset:16384
    ds_read_b64_tr_b16 v[226:227], v236 offset:17408
    v_mfma_f32_32x32x16_bf16 v[160:175], v[212:215], v[72:75], v[160:175]
    ds_read_b64_tr_b16 v[228:229], v237 offset:16384
    ds_read_b64_tr_b16 v[230:231], v237 offset:17408
    s_add_u32 s67, s14, 24576
    buffer_load_dwordx4 v[104:107], v254, s[28:31], s67 offen offset:2048 sc1
    s_lshr_b32 s68, s74, 1
    s_waitcnt vmcnt(8)
    v_cmp_ne_u32 vcc, 0, v248
    s_nop 3
    s_and_b32 s66, vcc_lo, 0xff
    s_cmp_eq_u32 s66, 0xff
    s_cbranch_scc1 L_pc13
    s_add_u32 s66, s68, 56
    s_lshl_b32 s66, s66, 7
    v_and_b32 v239, 15, v255
    v_lshlrev_b32 v239, 2, v239
    v_add_u32 v239, s66, v239
    s_mov_b32 s78, 0x40000
L_spin14:
    buffer_load_dword v252, v239, s[36:39], 0 offen sc1
    s_waitcnt vmcnt(0)
    v_cmp_ne_u32 vcc, 0, v252
    s_nop 3
    s_and_b32 s66, vcc_lo, 0xff
    s_cmp_eq_u32 s66, 0xff
    s_cbranch_scc1 L_spun14
    s_sleep 8
    s_sub_u32 s78, s78, 1
    s_cbranch_scc0 L_spin14
L_spun14:
L_pc13:
    s_waitcnt lgkmcnt(4)
    v_mfma_f32_32x32x16_bf16 v[144:159], v[216:219], v[76:79], v[144:159]
    ds_read_b64_tr_b16 v[208:209], v236 offset:18432
    ds_read_b64_tr_b16 v[210:211], v236 offset:19456
    v_mfma_f32_32x32x16_bf16 v[160:175], v[220:223], v[76:79], v[160:175]
    ds_read_b64_tr_b16 v[212:213], v237 offset:18432
    ds_read_b64_tr_b16 v[214:215], v237 offset:19456
    s_add_u32 s67, s14, 24576
    buffer_load_dwordx4 v[108:111], v254, s[28:31], s67 offen offset:3072 sc1
    s_barrier
    s_waitcnt lgkmcnt(4)
    v_mfma_f32_32x32x16_bf16 v[144:159], v[224:227], v[80:83], v[144:159]
    v_add_u32 v236, 0xffff0000, v236
    v_add_u32 v237, 0xffff0000, v237
    ds_read_b64_tr_b16 v[216:217], v236 offset:16384
    ds_read_b64_tr_b16 v[218:219], v236 offset:17408
    s_add_u32 s66, s51, 32768
    s_add_u32 m0, s73, 131072
    s_nop 0
    buffer_load_dwordx4 v253, s[44:47], s66 offen lds
    v_mfma_f32_32x32x16_bf16 v[160:175], v[228:231], v[80:83], v[160:175]
    ds_read_b64_tr_b16 v[220:221], v237 offset:16384
    ds_read_b64_tr_b16 v[222:223], v237 offset:17408
    s_add_u32 s66, s51, 40960
    s_add_u32 m0, s73, 132096
    s_nop 0
    buffer_load_dwordx4 v253, s[44:47], s66 offen lds
    s_add_u32 s67, s15, 28672
    buffer_load_dwordx4 v[112:115], v254, s[28:31], s67 offen offset:0 sc1
    s_waitcnt lgkmcnt(4)
    v_mfma_f32_32x32x16_bf16 v[144:159], v[208:211], v[84:87], v[144:159]
    ds_read_b64_tr_b16 v[224:225], v236 offset:18432
    ds_read_b64_tr_b16 v[226:227], v236 offset:19456
    v_mfma_f32_32x32x16_bf16 v[160:175], v[212:215], v[84:87], v[160:175]
    ds_read_b64_tr_b16 v[228:229], v237 offset:18432
    ds_read_b64_tr_b16 v[230:231], v237 offset:19456
    s_add_u32 s67, s15, 28672
    buffer_load_dwordx4 v[116:119], v254, s[28:31], s67 offen offset:1024 sc1
    s_waitcnt lgkmcnt(4)
    v_mfma_f32_32x32x16_bf16 v[144:159], v[216:219], v[88:91], v[144:159]
    v_add_u32 v236, 0x10000, v236
    v_add_u32 v237, 0x10000, v237
    ds_read_b64_tr_b16 v[208:209], v236 offset:32768
    ds_read_b64_tr_b16 v[210:211], v236 offset:33792
    v_mfma_f32_32x32x16_bf16 v[160:175], v[220:223], v[88:91], v[160:175]
    ds_read_b64_tr_b16 v[212:213], v237 offset:32768
    ds_read_b64_tr_b16 v[214:215], v237 offset:33792
    s_add_u32 s67, s15, 28672
    buffer_load_dwordx4 v[120:123], v254, s[28:31], s67 offen offset:2048 sc1
    s_waitcnt lgkmcnt(4)
    s_waitcnt vmcnt(13)
    v_mfma_f32_32x32x16_bf16 v[144:159], v[224:227], v[92:95], v[144:159]
    ds_read_b64_tr_b16 v[216:217], v236 offset:34816
    ds_read_b64_tr_b16 v[218:219], v236 offset:35840
    v_mfma_f32_32x32x16_bf16 v[160:175], v[228:231], v[92:95], v[160:175]
    ds_read_b64_tr_b16 v[220:221], v237 offset:34816
    ds_read_b64_tr_b16 v[222:223], v237 offset:35840
    s_add_u32 s67, s15, 28672
    buffer_load_dwordx4 v[124:127], v254, s[28:31], s67 offen offset:3072 sc1
    s_waitcnt vmcnt(9)
    s_barrier
    s_waitcnt lgkmcnt(4)
    v_mfma_f32_32x32x16_bf16 v[144:159], v[208:211], v[96:99], v[144:159]
    ds_read_b64_tr_b16 v[224:225], v236 offset:0
    ds_read_b64_tr_b16 v[226:227], v236 offset:1024
    s_add_u32 s66, s51, 65536
    s_add_u32 m0, s73, 81920
    s_nop 0
    buffer_load_dwordx4 v253, s[44:47], s66 offen lds
    v_mfma_f32_32x32x16_bf16 v[160:175], v[212:215], v[96:99], v[160:175]
    ds_read_b64_tr_b16 v[228:229], v237 offset:0
    ds_read_b64_tr_b16 v[230:231], v237 offset:1024
    s_add_u32 s66, s51, 73728
    s_add_u32 m0, s73, 82944
    s_nop 0
    buffer_load_dwordx4 v253, s[44:47], s66 offen lds
    s_add_u32 s67, s15, 32768
    buffer_load_dwordx4 v[128:131], v254, s[28:31], s67 offen offset:0 sc1
    s_waitcnt lgkmcnt(4)
    s_waitcnt vmcnt(11)
    v_mfma_f32_32x32x16_bf16 v[144:159], v[216:219], v[100:103], v[144:159]
    ds_read_b64_tr_b16 v[208:209], v236 offset:2048
    ds_read_b64_tr_b16 v[210:211], v236 offset:3072
    v_mfma_f32_32x32x16_bf16 v[160:175], v[220:223], v[100:103], v[160:175]
    ds_read_b64_tr_b16 v[212:213], v237 offset:2048
    ds_read_b64_tr_b16 v[214:215], v237 offset:3072
    s_add_u32 s67, s15, 32768
    buffer_load_dwordx4 v[132:135], v254, s[28:31], s67 offen offset:1024 sc1
    s_waitcnt lgkmcnt(4)
    s_waitcnt vmcnt(11)
    v_mfma_f32_32x32x16_bf16 v[144:159], v[224:227], v[104:107], v[144:159]
    ds_read_b64_tr_b16 v[216:217], v236 offset:49152
    ds_read_b64_tr_b16 v[218:219], v236 offset:50176
    v_mfma_f32_32x32x16_bf16 v[160:175], v[228:231], v[104:107], v[160:175]
    ds_read_b64_tr_b16 v[220:221], v237 offset:49152
    ds_read_b64_tr_b16 v[222:223], v237 offset:50176
    s_add_u32 s67, s15, 32768
    buffer_load_dwordx4 v[136:139], v254, s[28:31], s67 offen offset:2048 sc1
    s_waitcnt lgkmcnt(4)
    s_waitcnt vmcnt(11)
    v_mfma_f32_32x32x16_bf16 v[144:159], v[208:211], v[108:111], v[144:159]
    ds_read_b64_tr_b16 v[224:225], v236 offset:51200
    ds_read_b64_tr_b16 v[226:227], v236 offset:52224
    v_mfma_f32_32x32x16_bf16 v[160:175], v[212:215], v[108:111], v[160:175]
    ds_read_b64_tr_b16 v[228:229], v237 offset:51200
    ds_read_b64_tr_b16 v[230:231], v237 offset:52224
    s_add_u32 s67, s15, 32768
    buffer_load_dwordx4 v[140:143], v254, s[28:31], s67 offen offset:3072 sc1
    s_waitcnt vmcnt(4)
    s_barrier
    s_waitcnt lgkmcnt(4)
    v_mfma_f32_32x32x16_bf16 v[176:191], v[216:219], v[112:115], 0
    v_add_u32 v236, 0x10000, v236
    v_add_u32 v237, 0x10000, v237
    ds_read_b64_tr_b16 v[208:209], v236 offset:0
    ds_read_b64_tr_b16 v[210:211], v236 offset:1024
    s_add_u32 s66, s51, 98304
    s_add_u32 m0, s73, 65536
    s_nop 0
    buffer_load_dwordx4 v253, s[44:47], s66 offen lds
    v_and_b32 v1, 63, v255
    v_and_b32 v2, 31, v1
    v_mfma_f32_32x32x16_bf16 v[192:207], v[220:223], v[112:115], 0
    ds_read_b64_tr_b16 v[212:213], v237 offset:0
    ds_read_b64_tr_b16 v[214:215], v237 offset:1024
    s_add_u32 s66, s51, 106496
    s_add_u32 m0, s73, 66560
    s_nop 0
    buffer_load_dwordx4 v253, s[44:47], s66 offen lds
    v_lshrrev_b32 v3, 5, v1
    v_and_b32 v4, 15, v2
    s_waitcnt lgkmcnt(4)
    v_mfma_f32_32x32x16_bf16 v[176:191], v[224:227], v[116:119], v[176:191]
    ds_read_b64_tr_b16 v[216:217], v236 offset:2048
    ds_read_b64_tr_b16 v[218:219], v236 offset:3072
    v_xor_b32 v4, v4, v3
    v_lshlrev_b32 v240, 8, v2
    v_mfma_f32_32x32x16_bf16 v[192:207], v[228:231], v[116:119], v[192:207]
    ds_read_b64_tr_b16 v[220:221], v237 offset:2048
    ds_read_b64_tr_b16 v[222:223], v237 offset:3072
    v_lshl_add_u32 v240, v4, 4, v240
    s_lshl_b32 s66, s49, 15
    s_lshl_b32 s68, s48, 13
    s_add_u32 s66, s66, s68
    v_add_u32 v240, s66, v240
    s_waitcnt lgkmcnt(4)
    v_mfma_f32_32x32x16_bf16 v[176:191], v[208:211], v[120:123], v[176:191]
    v_add_u32 v236, 0xffff0000, v236
    v_add_u32 v237, 0xffff0000, v237
    ds_read_b64_tr_b16 v[224:225], v236 offset:16384
    ds_read_b64_tr_b16 v[226:227], v236 offset:17408
    v_xor_b32 v5, 0, v240
    ds_write_b128 v5, v[144:147]
    v_xor_b32 v6, 32, v240
    ds_write_b128 v6, v[148:151]
    v_mfma_f32_32x32x16_bf16 v[192:207], v[212:215], v[120:123], v[192:207]
    ds_read_b64_tr_b16 v[228:229], v237 offset:16384
    ds_read_b64_tr_b16 v[230:231], v237 offset:17408
    v_xor_b32 v5, 64, v240
    ds_write_b128 v5, v[152:155]
    v_xor_b32 v6, 96, v240
    ds_write_b128 v6, v[156:159]
    s_waitcnt lgkmcnt(8)
    v_mfma_f32_32x32x16_bf16 v[176:191], v[216:219], v[124:127], v[176:191]
    ds_read_b64_tr_b16 v[208:209], v236 offset:18432
    ds_read_b64_tr_b16 v[210:211], v236 offset:19456
    v_xor_b32 v5, 128, v240
    ds_write_b128 v5, v[160:163]
    v_xor_b32 v6, 160, v240
    ds_write_b128 v6, v[164:167]
    v_mfma_f32_32x32x16_bf16 v[192:207], v[220:223], v[124:127], v[192:207]
    ds_read_b64_tr_b16 v[212:213], v237 offset:18432
    ds_read_b64_tr_b16 v[214:215], v237 offset:19456
    v_xor_b32 v5, 192, v240
    ds_write_b128 v5, v[168:171]
    v_xor_b32 v6, 224, v240
    ds_write_b128 v6, v[172:175]
    s_waitcnt lgkmcnt(0)
    s_waitcnt vmcnt(0)
    s_barrier
    v_mfma_f32_32x32x16_bf16 v[176:191], v[224:227], v[128:131], v[176:191]
    ds_read_b64_tr_b16 v[216:217], v236 offset:0
    ds_read_b64_tr_b16 v[218:219], v236 offset:1024
    v_lshrrev_b32 v1, 3, v255
    v_and_b32 v2, 31, v1
    v_lshrrev_b32 v3, 5, v1
    v_lshlrev_b32 v3, 15, v3
    v_lshl_add_u32 v242, v2, 8, v3
    v_and_b32 v2, 15, v2
    v_and_b32 v4, 7, v255
    v_lshlrev_b32 v4, 1, v4
    v_xor_b32 v4, v4, v2
    v_lshl_add_u32 v242, v4, 4, v242
    v_xor_b32 v243, 16, v242
    ds_read_b128 v[64:67], v242 offset:0
    v_mfma_f32_32x32x16_bf16 v[192:207], v[228:231], v[128:131], v[192:207]
    ds_read_b64_tr_b16 v[220:221], v237 offset:0
    ds_read_b64_tr_b16 v[222:223], v237 offset:1024
    ds_read_b128 v[68:71], v243 offset:0
    ds_read_b128 v[72:75], v242 offset:8192
    ds_read_b128 v[76:79], v243 offset:8192
    ds_read_b128 v[80:83], v242 offset:16384
    ds_read_b128 v[84:87], v243 offset:16384
    ds_read_b128 v[88:91], v242 offset:24576
    ds_read_b128 v[92:95], v243 offset:24576
    s_waitcnt lgkmcnt(5)
    v_add_f32 v8, v64, v72
    s_waitcnt lgkmcnt(1)
    v_add_f32 v16, v80, v88
    v_add_f32 v9, v65, v73
    v_add_f32 v17, v81, v89
    v_add_f32 v10, v66, v74
    v_mfma_f32_32x32x16_bf16 v[176:191], v[208:211], v[132:135], v[176:191]
    ds_read_b64_tr_b16 v[224:225], v236 offset:2048
    ds_read_b64_tr_b16 v[226:227], v236 offset:3072
    v_add_f32 v18, v82, v90
    v_add_f32 v11, v67, v75
    v_add_f32 v19, v83, v91
    v_add_f32 v12, v68, v76
    s_waitcnt lgkmcnt(2)
    v_add_f32 v20, v84, v92
    v_add_f32 v13, v69, v77
    v_add_f32 v21, v85, v93
    v_add_f32 v14, v70, v78
    v_add_f32 v22, v86, v94
    v_add_f32 v15, v71, v79
    v_add_f32 v23, v87, v95
    v_add_f32 v8, v8, v16
    v_mfma_f32_32x32x16_bf16 v[192:207], v[212:215], v[132:135], v[192:207]
    ds_read_b64_tr_b16 v[228:229], v237 offset:2048
    ds_read_b64_tr_b16 v[230:231], v237 offset:3072
    v_add_f32 v9, v9, v17
    v_add_f32 v10, v10, v18
    v_add_f32 v11, v11, v19
    v_add_f32 v12, v12, v20
    v_add_f32 v13, v13, v21
    v_add_f32 v14, v14, v22
    v_add_f32 v15, v15, v23
    v_mul_f32 v16, s70, v8
    v_mul_f32 v17, s70, v9
    v_mul_f32 v18, s70, v10
    v_mul_f32 v19, s70, v11
    v_mfma_f32_32x32x16_bf16 v[176:191], v[216:219], v[136:139], v[176:191]
    v_mul_f32 v20, s70, v12
    v_mul_f32 v21, s70, v13
    v_mul_f32 v22, s70, v14
    v_mul_f32 v23, s70, v15
    v_exp_f32 v16, -v16
    v_exp_f32 v17, -v17
    v_exp_f32 v18, -v18
    v_exp_f32 v19, -v19
    v_exp_f32 v20, -v20
    v_exp_f32 v21, -v21
    v_exp_f32 v22, -v22
    v_mfma_f32_32x32x16_bf16 v[192:207], v[220:223], v[136:139], v[192:207]
    v_exp_f32 v23, -v23
    v_add_f32 v16, 1.0, v16
    v_add_f32 v17, 1.0, v17
    v_add_f32 v18, 1.0, v18
    v_add_f32 v19, 1.0, v19
    v_add_f32 v20, 1.0, v20
    v_add_f32 v21, 1.0, v21
    v_add_f32 v22, 1.0, v22
    v_add_f32 v23, 1.0, v23
    v_rcp_f32 v16, v16
    v_rcp_f32 v17, v17
    s_waitcnt lgkmcnt(0)
    v_mfma_f32_32x32x16_bf16 v[176:191], v[224:227], v[140:143], v[176:191]
    v_rcp_f32 v18, v18
    v_rcp_f32 v19, v19
    v_rcp_f32 v20, v20
    v_rcp_f32 v21, v21
    v_rcp_f32 v22, v22
    v_rcp_f32 v23, v23
    v_mul_f32 v8, v8, v16
    v_mul_f32 v9, v9, v17
    v_mul_f32 v10, v10, v18
    v_mul_f32 v11, v11, v19
    v_mul_f32 v12, v12, v20
    v_mfma_f32_32x32x16_bf16 v[192:207], v[228:231], v[140:143], v[192:207]
    v_mul_f32 v13, v13, v21
    v_mul_f32 v14, v14, v22
    v_mul_f32 v15, v15, v23
    v_lshlrev_b32 v24, 16, v232
    v_and_b32 v25, 0xffff0000, v232
    v_lshlrev_b32 v26, 16, v233
    v_and_b32 v27, 0xffff0000, v233
    v_lshlrev_b32 v28, 16, v234
    v_and_b32 v29, 0xffff0000, v234
    v_lshlrev_b32 v30, 16, v235
    v_and_b32 v31, 0xffff0000, v235
    s_barrier
    v_xor_b32 v5, 0, v240
    ds_write_b128 v5, v[176:179]
    v_xor_b32 v6, 32, v240
    ds_write_b128 v6, v[180:183]
    v_xor_b32 v5, 64, v240
    ds_write_b128 v5, v[184:187]
    v_xor_b32 v6, 96, v240
    ds_write_b128 v6, v[188:191]
    v_xor_b32 v5, 128, v240
    ds_write_b128 v5, v[192:195]
    v_xor_b32 v6, 160, v240
    ds_write_b128 v6, v[196:199]
    v_xor_b32 v5, 192, v240
    ds_write_b128 v5, v[200:203]
    v_xor_b32 v6, 224, v240
    ds_write_b128 v6, v[204:207]
    s_waitcnt lgkmcnt(0)
    s_barrier
    ds_read_b128 v[64:67], v242 offset:0
    ds_read_b128 v[68:71], v243 offset:0
    ds_read_b128 v[72:75], v242 offset:8192
    ds_read_b128 v[76:79], v243 offset:8192
    ds_read_b128 v[80:83], v242 offset:16384
    ds_read_b128 v[84:87], v243 offset:16384
    ds_read_b128 v[88:91], v242 offset:24576
    ds_read_b128 v[92:95], v243 offset:24576
    s_waitcnt lgkmcnt(5)
    v_add_f32 v32, v64, v72
    s_waitcnt lgkmcnt(1)
    v_add_f32 v16, v80, v88
    v_add_f32 v33, v65, v73
    v_add_f32 v17, v81, v89
    v_add_f32 v34, v66, v74
    v_add_f32 v18, v82, v90
    v_add_f32 v35, v67, v75
    v_add_f32 v19, v83, v91
    v_add_f32 v36, v68, v76
    s_waitcnt lgkmcnt(0)
    v_add_f32 v20, v84, v92
    v_add_f32 v37, v69, v77
    v_add_f32 v21, v85, v93
    v_add_f32 v38, v70, v78
    v_add_f32 v22, v86, v94
    v_add_f32 v39, v71, v79
    v_add_f32 v23, v87, v95
    v_add_f32 v32, v32, v16
    v_add_f32 v33, v33, v17
    v_add_f32 v34, v34, v18
    v_add_f32 v35, v35, v19
    v_add_f32 v36, v36, v20
    v_add_f32 v37, v37, v21
    v_add_f32 v38, v38, v22
    v_add_f32 v39, v39, v23
    v_fma_f32 v32, v32, v8, v24
    v_fma_f32 v33, v33, v9, v25
    v_fma_f32 v34, v34, v10, v26
    v_fma_f32 v35, v35, v11, v27
    v_fma_f32 v36, v36, v12, v28
    v_fma_f32 v37, v37, v13, v29
    v_fma_f32 v38, v38, v14, v30
    v_fma_f32 v39, v39, v15, v31
    v_cvt_pk_bf16_f32 v56, v32, v33
    v_cvt_pk_bf16_f32 v57, v34, v35
    v_cvt_pk_bf16_f32 v58, v36, v37
    v_cvt_pk_bf16_f32 v59, v38, v39
    buffer_store_dwordx4 v[56:59], v238, s[20:23], 0 offen
    s_branch L_end
L_typeA:
    s_and_b32 s79, s60, 1
    s_add_u32 s79, s79, 1
    s_lshl_b32 s3, s65, 8
    s_lshr_b32 s66, s60, 1
    s_lshl_b32 s66, s66, 7
    s_add_u32 s3, s3, s66
    s_lshl_b32 s66, s65, 7
    s_and_b32 s67, s60, 1
    s_lshl_b32 s67, s67, 6
    s_add_u32 s66, s66, s67
    s_cmp_ge_u32 s60, 4
    s_cselect_b32 s79, 0, s79
    s_cselect_b32 s3, s66, s3
    s_cmp_eq_u32 s79, 0
    s_mov_b32 s66, 3072
    s_mov_b32 s67, 3584
    s_cmp_eq_u32 s79, 0
    s_cselect_b32 s68, s66, s67
    s_cmp_ge_u32 s60, 4
    s_cselect_b32 s66, 2, 3
    s_cselect_b32 s67, 3, 7
    v_lshrrev_b32 v245, s66, v244
    v_and_b32 v246, s67, v244
    v_mul_lo_u32 v245, v245, s68
    v_lshl_add_u32 v245, v246, 4, v245
    s_cmp_ge_u32 s60, 6
    s_cselect_b32 s66, 0x7ff00000, 0
    v_add_u32 v245, s66, v245
    s_lshl_b32 s66, s63, 5
    s_mul_i32 s66, s66, s68
    s_add_u32 s3, s3, s66
    s_mul_i32 s30, s68, 512
    s_mov_b32 s31, 0x20000
    s_cmp_ge_u32 s60, 4
    s_cselect_b32 s66, 4, 3
    s_lshl_b32 s68, s68, s66
    s_waitcnt lgkmcnt(0)
    s_lshl_b32 s66, s63, 17
    s_add_u32 s16, s4, s66
    s_addc_u32 s17, s5, 0
    s_mov_b32 s18, 131072
    s_mov_b32 s19, 0x20000
    s_lshl_b32 s66, s64, 3
    s_add_u32 s66, s66, s60
    s_lshl_b32 s66, s66, 10
    buffer_load_dwordx4 v[128:131], v254, s[16:19], s66 offen
    s_cmp_eq_u32 s79, 1
    s_cselect_b32 s28, s52, s6
    s_cselect_b32 s29, s53, s7
    s_cmp_eq_u32 s79, 2
    s_cselect_b32 s28, s54, s28
    s_cselect_b32 s29, s55, s29
    buffer_load_dwordx4 v[160:163], v245, s[28:31], s3 offen
    s_add_u32 s3, s3, s68
    buffer_load_dwordx4 v[164:167], v245, s[28:31], s3 offen
    s_add_u32 s3, s3, s68
    s_and_b32 s66, s60, 6
    s_cmp_eq_u32 s66, 4
    s_cselect_b32 s66, 0x7ff00000, 0
    v_add_u32 v245, s66, v245
    buffer_load_dwordx4 v[168:171], v245, s[28:31], s3 offen
    s_add_u32 s3, s3, s68
    buffer_load_dwordx4 v[172:175], v245, s[28:31], s3 offen
    s_mov_b32 s66, 10616832
    s_add_u32 s36, s58, s66
    s_addc_u32 s37, s59, 0
    s_mov_b32 s38, 458752
    s_mov_b32 s39, 0x20000
    v_lshlrev_b32 v180, 4, v255
    v_mov_b32 v176, 0
    v_mov_b32 v177, 0
    v_mov_b32 v178, 0
    v_mov_b32 v179, 0
    s_cmp_eq_u32 s2, 0
    s_cselect_b32 s66, 0, 0x7ff00000
    v_add_u32 v180, s66, v180
    buffer_store_dwordx4 v[176:179], v180, s[36:39], 0 offen sc1
    s_mov_b32 s66, 8192
    buffer_store_dwordx4 v[176:179], v180, s[36:39], s66 offen sc1
    s_lshl_b32 s66, s60, 14
    s_add_u32 s66, s66, 0
    s_lshl_b32 m0, s60, 12
    s_add_u32 m0, m0, 0
    s_nop 0
    buffer_load_dwordx4 v240, s[16:19], s66 offen lds
    s_lshl_b32 s66, s60, 14
    s_add_u32 s66, s66, 4096
    s_lshl_b32 m0, s60, 12
    s_add_u32 m0, m0, 1024
    s_nop 0
    buffer_load_dwordx4 v241, s[16:19], s66 offen lds
    s_lshl_b32 s66, s60, 14
    s_add_u32 s66, s66, 8192
    s_lshl_b32 m0, s60, 12
    s_add_u32 m0, m0, 2048
    s_nop 0
    buffer_load_dwordx4 v242, s[16:19], s66 offen lds
    s_lshl_b32 s66, s60, 14
    s_add_u32 s66, s66, 12288
    s_lshl_b32 m0, s60, 12
    s_add_u32 m0, m0, 3072
    s_nop 0
    buffer_load_dwordx4 v243, s[16:19], s66 offen lds
    v_and_b32 v247, 63, v255
    v_lshrrev_b32 v248, 3, v247
    v_mul_u32_u24 v218, 3584, v248
    v_and_b32 v248, 7, v247
    v_bfe_u32 v249, v247, 4, 1
    v_lshlrev_b32 v249, 1, v249
    v_xor_b32 v248, v248, v249
    v_lshl_add_u32 v218, v248, 4, v218
    v_xor_b32 v219, 64, v218
    s_mov_b32 s20, s52
    s_mov_b32 s21, s53
    s_mov_b32 s22, 1835008
    s_mov_b32 s23, 0x20000
    s_mov_b32 s24, s54
    s_mov_b32 s25, s55
    s_mov_b32 s26, 1835008
    s_mov_b32 s27, 0x20000
    s_lshl_b32 s14, s65, 8
    s_mul_i32 s66, s60, 28672
    s_add_u32 s14, s14, s66
    s_mov_b32 s15, s14
    s_lshl_b32 s69, s60, 10
    s_add_u32 s66, s14, 0
    s_add_u32 m0, s69, 131072
    s_nop 0
    buffer_load_dwordx4 v218, s[20:23], s66 offen lds
    s_add_u32 s66, s15, 0
    s_add_u32 m0, s69, 139264
    s_nop 0
    buffer_load_dwordx4 v219, s[24:27], s66 offen lds
    s_add_u32 s66, s14, 229376
    s_add_u32 m0, s69, 114688
    s_nop 0
    buffer_load_dwordx4 v218, s[20:23], s66 offen lds
    s_add_u32 s66, s15, 229376
    s_add_u32 m0, s69, 122880
    s_nop 0
    buffer_load_dwordx4 v219, s[24:27], s66 offen lds
    s_barrier
    s_lshl_b32 s66, s60, 14
    s_add_u32 s66, s66, 256
    s_lshl_b32 m0, s60, 12
    s_add_u32 m0, m0, 32768
    s_nop 0
    buffer_load_dwordx4 v240, s[16:19], s66 offen lds
    s_lshl_b32 s66, s60, 14
    s_add_u32 s66, s66, 4352
    s_lshl_b32 m0, s60, 12
    s_add_u32 m0, m0, 33792
    s_nop 0
    buffer_load_dwordx4 v241, s[16:19], s66 offen lds
    s_lshl_b32 s66, s60, 14
    s_add_u32 s66, s66, 8448
    s_lshl_b32 m0, s60, 12
    s_add_u32 m0, m0, 34816
    s_nop 0
    buffer_load_dwordx4 v242, s[16:19], s66 offen lds
    s_lshl_b32 s66, s60, 14
    s_add_u32 s66, s66, 12544
    s_lshl_b32 m0, s60, 12
    s_add_u32 m0, m0, 35840
    s_nop 0
    buffer_load_dwordx4 v243, s[16:19], s66 offen lds
    s_mul_i32 s66, s65, 69632
    s_add_u32 s66, s66, 11010048
    s_add_u32 s32, s58, s66
    s_addc_u32 s33, s59, 0
    s_mov_b32 s34, 69632
    s_mov_b32 s35, 0x20000
    s_lshl_b32 s66, s63, 2
    s_add_u32 s66, s66, s61
    s_mul_i32 s66, s66, 147456
    s_add_u32 s28, s58, s66
    s_addc_u32 s29, s59, 0
    s_mov_b32 s30, 147456
    s_mov_b32 s31, 0x20000
    v_mov_b32 v226, 0
    v_mov_b32 v227, 0
    v_mov_b32 v230, 0
    v_mov_b32 v231, 0
    v_and_b32 v245, 31, v255
    v_bfe_u32 v246, v255, 5, 1
    v_and_b32 v232, 15, v245
    v_xor_b32 v246, v232, v246
    s_lshl_b32 s66, s61, 5
    v_add_u32 v245, s66, v245
    v_lshlrev_b32 v232, 8, v245
    v_lshl_add_u32 v232, v246, 4, v232
    v_xor_b32 v233, 32, v232
    v_xor_b32 v234, 64, v232
    v_xor_b32 v235, 96, v232
    v_xor_b32 v236, 128, v232
    v_xor_b32 v237, 160, v232
    v_xor_b32 v238, 192, v232
    v_xor_b32 v239, 224, v232
    v_and_b32 v247, 63, v255
    v_lshrrev_b32 v248, 5, v247
    v_lshlrev_b32 v248, 3, v248
    v_bfe_u32 v249, v247, 2, 2
    v_add_u32 v248, v248, v249
    v_lshlrev_b32 v216, 7, v248
    v_bfe_u32 v248, v247, 1, 1
    v_bfe_u32 v249, v247, 4, 1
    s_lshl_b32 s66, s62, 2
    v_add_u32 v248, s66, v248
    v_lshl_add_u32 v216, v249, 13, v216
    v_lshlrev_b32 v249, 2, v249
    v_xor_b32 v248, v248, v249
    v_bfe_u32 v249, v247, 3, 1
    v_lshlrev_b32 v249, 1, v249
    v_xor_b32 v248, v248, v249
    v_lshl_add_u32 v216, v248, 4, v216
    v_and_b32 v248, 1, v247
    v_lshl_add_u32 v216, v248, 3, v216
    v_add_u32 v216, 0x20000, v216
    v_xor_b32 v217, 32, v216
    s_waitcnt vmcnt(18)
    v_lshlrev_b32 v136, 16, v128
    v_and_b32 v137, 0xffff0000, v128
    v_lshlrev_b32 v138, 16, v129
    v_and_b32 v139, 0xffff0000, v129
    v_lshlrev_b32 v140, 16, v130
    v_and_b32 v141, 0xffff0000, v130
    v_lshlrev_b32 v142, 16, v131
    v_and_b32 v143, 0xffff0000, v131
    v_add_f32 v144, v136, v137
    v_mul_f32 v145, v136, v136
    v_add_f32 v144, v144, v138
    v_add_f32 v144, v144, v139
    v_add_f32 v144, v144, v140
    v_add_f32 v144, v144, v141
    v_add_f32 v144, v144, v142
    v_add_f32 v144, v144, v143
    v_fma_f32 v145, v137, v137, v145
    v_fma_f32 v145, v138, v138, v145
    v_fma_f32 v145, v139, v139, v145
    v_fma_f32 v145, v140, v140, v145
    v_fma_f32 v145, v141, v141, v145
    v_fma_f32 v145, v142, v142, v145
    v_fma_f32 v145, v143, v143, v145
    v_mov_b32_dpp v136, v144 row_shr:1 row_mask:0xf bank_mask:0xf bound_ctrl:1
    s_nop 0
    v_mov_b32_dpp v137, v145 row_shr:1 row_mask:0xf bank_mask:0xf bound_ctrl:1
    v_add_f32 v144, v144, v136
    v_add_f32 v145, v145, v137
    s_nop 0
    v_mov_b32_dpp v136, v144 row_shr:2 row_mask:0xf bank_mask:0xf bound_ctrl:1
    v_mov_b32_dpp v137, v145 row_shr:2 row_mask:0xf bank_mask:0xf bound_ctrl:1
    v_add_f32 v144, v144, v136
    v_add_f32 v145, v145, v137
    s_nop 0
    v_mov_b32_dpp v136, v144 row_shr:4 row_mask:0xf bank_mask:0xf bound_ctrl:1
    v_mov_b32_dpp v137, v145 row_shr:4 row_mask:0xf bank_mask:0xf bound_ctrl:1
    v_add_f32 v144, v144, v136
    v_add_f32 v145, v145, v137
    s_nop 0
    v_mov_b32_dpp v136, v144 row_shr:8 row_mask:0xf bank_mask:0xf bound_ctrl:1
    v_mov_b32_dpp v137, v145 row_shr:8 row_mask:0xf bank_mask:0xf bound_ctrl:1
    v_add_f32 v144, v144, v136
    v_add_f32 v145, v145, v137
    v_mov_b32 v136, 0
    v_mov_b32 v137, 0
    s_nop 0
    v_mov_b32_dpp v136, v144 row_bcast:15 row_mask:0xa bank_mask:0xf
    v_mov_b32_dpp v137, v145 row_bcast:15 row_mask:0xa bank_mask:0xf
    v_add_f32 v144, v144, v136
    v_add_f32 v145, v145, v137
    v_mov_b32 v136, 0
    v_mov_b32 v137, 0
    s_nop 0
    v_mov_b32_dpp v136, v144 row_bcast:31 row_mask:0xc bank_mask:0xf
    v_mov_b32_dpp v137, v145 row_bcast:31 row_mask:0xc bank_mask:0xf
    v_add_f32 v144, v144, v136
    v_add_f32 v145, v145, v137
    v_mul_f32 v144, 0x3b000000, v144
    v_mul_f32 v145, 0x3b000000, v145
    v_fma_f32 v145, -v144, v144, v145
    v_add_f32 v145, 0x3727c5ac, v145
    v_rsq_f32 v139, v145
    v_sub_f32 v138, 0, v144
    v_and_b32 v140, 63, v255
    s_lshl_b32 s68, s63, 7
    s_lshl_b32 s67, s64, 3
    s_add_u32 s68, s68, s67
    s_add_u32 s68, s68, s60
    s_lshl_b32 s68, s68, 3
    s_add_u32 s68, s68, 65536
    v_mov_b32 v141, s68
    v_mov_b32 v142, 0x7ff00000
    v_cmp_eq_u32 vcc, 63, v140
    s_nop 1
    v_cndmask_b32 v141, v142, v141, vcc
    buffer_store_dwordx2 v[138:139], v141, s[36:39], 0 offen sc1
    s_waitcnt vmcnt(18)
    v_lshlrev_b32 v144, 16, v160
    v_and_b32 v145, 0xffff0000, v160
    v_lshlrev_b32 v146, 16, v161
    v_and_b32 v147, 0xffff0000, v161
    v_lshlrev_b32 v148, 16, v162
    v_and_b32 v149, 0xffff0000, v162
    v_lshlrev_b32 v150, 16, v163
    v_and_b32 v151, 0xffff0000, v163
    s_waitcnt vmcnt(17)
    v_lshlrev_b32 v152, 16, v164
    v_and_b32 v153, 0xffff0000, v164
    v_lshlrev_b32 v154, 16, v165
    v_and_b32 v155, 0xffff0000, v165
    v_lshlrev_b32 v156, 16, v166
    v_and_b32 v157, 0xffff0000, v166
    v_lshlrev_b32 v158, 16, v167
    v_and_b32 v159, 0xffff0000, v167
    v_add_f32 v144, v144, v152
    v_add_f32 v145, v145, v153
    v_add_f32 v146, v146, v154
    v_add_f32 v147, v147, v155
    v_add_f32 v148, v148, v156
    v_add_f32 v149, v149, v157
    v_add_f32 v150, v150, v158
    v_add_f32 v151, v151, v159
    s_waitcnt vmcnt(16)
    v_lshlrev_b32 v152, 16, v168
    v_and_b32 v153, 0xffff0000, v168
    v_lshlrev_b32 v154, 16, v169
    v_and_b32 v155, 0xffff0000, v169
    v_lshlrev_b32 v156, 16, v170
    v_and_b32 v157, 0xffff0000, v170
    v_lshlrev_b32 v158, 16, v171
    v_and_b32 v159, 0xffff0000, v171
    v_add_f32 v144, v144, v152
    v_add_f32 v145, v145, v153
    v_add_f32 v146, v146, v154
    v_add_f32 v147, v147, v155
    v_add_f32 v148, v148, v156
    v_add_f32 v149, v149, v157
    v_add_f32 v150, v150, v158
    v_add_f32 v151, v151, v159
    s_waitcnt vmcnt(15)
    v_lshlrev_b32 v152, 16, v172
    v_and_b32 v153, 0xffff0000, v172
    v_lshlrev_b32 v154, 16, v173
    v_and_b32 v155, 0xffff0000, v173
    v_lshlrev_b32 v156, 16, v174
    v_and_b32 v157, 0xffff0000, v174
    v_lshlrev_b32 v158, 16, v175
    v_and_b32 v159, 0xffff0000, v175
    v_add_f32 v144, v144, v152
    v_add_f32 v145, v145, v153
    v_add_f32 v146, v146, v154
    v_add_f32 v147, v147, v155
    v_add_f32 v148, v148, v156
    v_add_f32 v149, v149, v157
    v_add_f32 v150, v150, v158
    v_add_f32 v151, v151, v159
    v_and_b32 v136, 63, v255
    v_bfe_u32 v137, v136, 2, 3
    v_lshlrev_b32 v137, 3, v137
    v_bfe_u32 v138, v136, 5, 1
    v_lshl_add_u32 v137, v138, 2, v137
    v_and_b32 v138, 3, v136
    v_add_u32 v137, v137, v138
    s_and_b32 s68, s60, 6
    s_cmp_eq_u32 s68, 4
    s_cselect_b32 s68, 1, 0
    v_mov_b32 v138, s68
    v_cmp_eq_u32 vcc, 1, v138
    s_nop 1
    v_cndmask_b32 v136, v136, v137, vcc
    v_lshlrev_b32 v136, 5, v136
    s_lshl_b32 s68, s60, 11
    s_add_u32 s68, s68, 147456
    v_add_u32 v136, s68, v136
    ds_write_b128 v136, v[144:147]
    ds_write_b128 v136, v[148:151] offset:16
    s_waitcnt vmcnt(7)
    s_waitcnt lgkmcnt(0)
    s_barrier
    s_cmp_lg_u32 s2, 0
    s_cbranch_scc1 L_zfa15
    v_mov_b32 v250, 0
    v_mov_b32 v251, 1
    global_store_dword v250, v251, s[56:57] sc1
    s_nop 1
L_zfa15:
    ds_read_b128 v[0:3], v232 offset:0
    ds_read_b128 v[4:7], v233 offset:0
    ds_read_b128 v[8:11], v234 offset:0
    ds_read_b128 v[12:15], v235 offset:0
    ds_read_b128 v[16:19], v236 offset:0
    ds_read_b128 v[20:23], v237 offset:0
    ds_read_b128 v[24:27], v238 offset:0
    ds_read_b128 v[28:31], v239 offset:0
    ds_read_b64_tr_b16 v[192:193], v216 offset:0
    ds_read_b64_tr_b16 v[194:195], v216 offset:512
    ds_read_b64_tr_b16 v[196:197], v217 offset:0
    ds_read_b64_tr_b16 v[198:199], v217 offset:512
    ds_read_b64_tr_b16 v[200:201], v216 offset:2048
    ds_read_b64_tr_b16 v[202:203], v216 offset:2560
    ds_read_b64_tr_b16 v[204:205], v217 offset:2048
    ds_read_b64_tr_b16 v[206:207], v217 offset:2560
    s_waitcnt vmcnt(5)
    s_waitcnt lgkmcnt(0)
    s_barrier
    v_mfma_f32_32x32x16_bf16 v[128:143], v[192:195], v[0:3], 0
    ds_read_b64_tr_b16 v[208:209], v216 offset:4096
    ds_read_b64_tr_b16 v[210:211], v216 offset:4608
    s_add_u32 s66, s14, 458752
    s_add_u32 m0, s69, 98304
    s_nop 0
    buffer_load_dwordx4 v218, s[20:23], s66 offen lds
    s_add_u32 s66, s15, 458752
    s_add_u32 m0, s69, 106496
    s_nop 0
    buffer_load_dwordx4 v219, s[24:27], s66 offen lds
    v_and_b32 v177, 63, v255
    v_and_b32 v178, 7, v177
    v_lshlrev_b32 v178, 2, v178
    v_lshrrev_b32 v179, 3, v177
    v_lshl_add_u32 v182, v179, 5, v178
    s_lshl_b32 s68, s60, 11
    s_add_u32 s68, s68, 147456
    v_add_u32 v180, s68, v182
    v_mfma_f32_32x32x16_bf16 v[144:159], v[196:199], v[0:3], 0
    ds_read_b64_tr_b16 v[212:213], v217 offset:4096
    ds_read_b64_tr_b16 v[214:215], v217 offset:4608
    s_add_u32 s66, s14, 688128
    s_add_u32 m0, s69, 81920
    s_nop 0
    buffer_load_dwordx4 v218, s[20:23], s66 offen lds
    s_add_u32 s66, s15, 688128
    s_add_u32 m0, s69, 90112
    s_nop 0
    buffer_load_dwordx4 v219, s[24:27], s66 offen lds
    v_add_u32 v181, 0x27000, v182
    v_and_b32 v182, 3, v179
    v_lshl_add_u32 v182, v182, 5, v178
    v_lshrrev_b32 v179, 2, v179
    v_lshl_add_u32 v182, v179, 11, v182
    v_add_u32 v182, 0x26000, v182
    v_add_u32 v183, 128, v182
    v_mfma_f32_32x32x16_bf16 v[128:143], v[200:203], v[4:7], v[128:143]
    ds_read_b64_tr_b16 v[192:193], v216 offset:6144
    ds_read_b64_tr_b16 v[194:195], v216 offset:6656
    s_lshl_b32 s66, s60, 14
    s_add_u32 s66, s66, 512
    s_lshl_b32 m0, s60, 12
    s_add_u32 m0, m0, 0
    s_nop 0
    buffer_load_dwordx4 v240, s[16:19], s66 offen lds
    v_mov_b32 v179, s60
    v_cmp_eq_u32 vcc, 4, v179
    s_nop 1
    v_cndmask_b32 v180, v180, v182, vcc
    v_cndmask_b32 v181, v181, v183, vcc
    ds_read_b32 v160, v180 offset:0
    ds_read_b32 v161, v180 offset:256
    ds_read_b32 v162, v180 offset:512
    ds_read_b32 v163, v180 offset:768
    v_mfma_f32_32x32x16_bf16 v[144:159], v[204:207], v[4:7], v[144:159]
    ds_read_b64_tr_b16 v[196:197], v217 offset:6144
    ds_read_b64_tr_b16 v[198:199], v217 offset:6656
    s_lshl_b32 s66, s60, 14
    s_add_u32 s66, s66, 4608
    s_lshl_b32 m0, s60, 12
    s_add_u32 m0, m0, 1024
    s_nop 0
    buffer_load_dwordx4 v241, s[16:19], s66 offen lds
    ds_read_b32 v164, v180 offset:1024
    ds_read_b32 v165, v180 offset:1280
    ds_read_b32 v166, v180 offset:1536
    ds_read_b32 v167, v180 offset:1792
    ds_read_b32 v168, v181 offset:0
    ds_read_b32 v169, v181 offset:256
    ds_read_b32 v170, v181 offset:512
    s_waitcnt lgkmcnt(15)
    v_mfma_f32_32x32x16_bf16 v[128:143], v[208:211], v[8:11], v[128:143]
    v_add_u32 v216, 0xffff0000, v216
    v_add_u32 v217, 0xffff0000, v217
    ds_read_b64_tr_b16 v[200:201], v216 offset:49152
    ds_read_b64_tr_b16 v[202:203], v216 offset:49664
    s_lshl_b32 s66, s60, 14
    s_add_u32 s66, s66, 8704
    s_lshl_b32 m0, s60, 12
    s_add_u32 m0, m0, 2048
    s_nop 0
    buffer_load_dwordx4 v242, s[16:19], s66 offen lds
    ds_read_b32 v171, v181 offset:768
    ds_read_b32 v172, v181 offset:1024
    ds_read_b32 v173, v181 offset:1280
    ds_read_b32 v174, v181 offset:1536
    ds_read_b32 v175, v181 offset:1792
    v_lshlrev_b32 v176, 2, v255
    v_mfma_f32_32x32x16_bf16 v[144:159], v[212:215], v[8:11], v[144:159]
    ds_read_b64_tr_b16 v[204:205], v217 offset:49152
    ds_read_b64_tr_b16 v[206:207], v217 offset:49664
    s_lshl_b32 s66, s60, 14
    s_add_u32 s66, s66, 12800
    s_lshl_b32 m0, s60, 12
    s_add_u32 m0, m0, 3072
    s_nop 0
    buffer_load_dwordx4 v243, s[16:19], s66 offen lds
    v_mov_b32 v177, 0x7ff00000
    v_cmp_gt_u32 vcc, 320, v255
    s_nop 1
    v_cndmask_b32 v176, v177, v176, vcc
    s_waitcnt lgkmcnt(15)
    v_add_f32 v160, v160, v161
    v_add_f32 v162, v162, v163
    s_waitcnt lgkmcnt(14)
    v_add_f32 v164, v164, v165
    s_waitcnt lgkmcnt(12)
    v_add_f32 v166, v166, v167
    v_mfma_f32_32x32x16_bf16 v[128:143], v[192:195], v[12:15], v[128:143]
    ds_read_b64_tr_b16 v[208:209], v216 offset:51200
    ds_read_b64_tr_b16 v[210:211], v216 offset:51712
    s_add_u32 s66, s14, 917504
    s_add_u32 m0, s69, 65536
    s_nop 0
    buffer_load_dwordx4 v218, s[20:23], s66 offen lds
    s_waitcnt lgkmcnt(12)
    v_add_f32 v168, v168, v169
    s_waitcnt lgkmcnt(8)
    v_add_f32 v170, v170, v171
    s_waitcnt lgkmcnt(6)
    v_add_f32 v172, v172, v173
    s_waitcnt lgkmcnt(4)
    v_add_f32 v174, v174, v175
    v_add_f32 v160, v160, v162
    v_add_f32 v164, v164, v166
    v_mfma_f32_32x32x16_bf16 v[144:159], v[196:199], v[12:15], v[144:159]
    ds_read_b64_tr_b16 v[212:213], v217 offset:51200
    ds_read_b64_tr_b16 v[214:215], v217 offset:51712
    s_add_u32 s66, s15, 917504
    s_add_u32 m0, s69, 73728
    s_nop 0
    buffer_load_dwordx4 v219, s[24:27], s66 offen lds
    v_add_f32 v168, v168, v170
    v_add_f32 v172, v172, v174
    v_add_f32 v160, v160, v164
    v_add_f32 v168, v168, v172
    v_add_f32 v160, v160, v168
    s_lshl_b32 s68, s64, 4
    s_add_u32 s68, s68, s63
    s_mul_i32 s68, s68, 1280
    s_add_u32 s68, s68, 131072
    buffer_store_dword v160, v176, s[36:39], s68 offen sc1
    s_waitcnt vmcnt(9)
    s_barrier
    v_mov_b32 v250, 0
    global_load_dword v244, v250, s[56:57] sc1
    s_waitcnt lgkmcnt(4)
    v_mfma_f32_32x32x16_bf16 v[128:143], v[200:203], v[16:19], v[128:143]
    ds_read_b64_tr_b16 v[192:193], v216 offset:53248
    ds_read_b64_tr_b16 v[194:195], v216 offset:53760
    s_add_u32 s66, s14, 1146880
    s_add_u32 m0, s69, 131072
    s_nop 0
    buffer_load_dwordx4 v218, s[20:23], s66 offen lds
    ds_read_b128 v[32:35], v232 offset:32768
    v_mfma_f32_32x32x16_bf16 v[144:159], v[204:207], v[16:19], v[144:159]
    ds_read_b64_tr_b16 v[196:197], v217 offset:53248
    ds_read_b64_tr_b16 v[198:199], v217 offset:53760
    s_add_u32 s66, s15, 1146880
    s_add_u32 m0, s69, 139264
    s_nop 0
    buffer_load_dwordx4 v219, s[24:27], s66 offen lds
    ds_read_b128 v[36:39], v233 offset:32768
    s_waitcnt lgkmcnt(6)
    v_mfma_f32_32x32x16_bf16 v[128:143], v[208:211], v[20:23], v[128:143]
    ds_read_b64_tr_b16 v[200:201], v216 offset:55296
    ds_read_b64_tr_b16 v[202:203], v216 offset:55808
    ds_read_b128 v[40:43], v234 offset:32768
    v_mfma_f32_32x32x16_bf16 v[144:159], v[212:215], v[20:23], v[144:159]
    ds_read_b64_tr_b16 v[204:205], v217 offset:55296
    ds_read_b64_tr_b16 v[206:207], v217 offset:55808
    ds_read_b128 v[44:47], v235 offset:32768
    s_waitcnt lgkmcnt(7)
    v_mfma_f32_32x32x16_bf16 v[128:143], v[192:195], v[24:27], v[128:143]
    ds_read_b64_tr_b16 v[208:209], v216 offset:32768
    ds_read_b64_tr_b16 v[210:211], v216 offset:33280
    ds_read_b128 v[48:51], v236 offset:32768
    v_mfma_f32_32x32x16_bf16 v[144:159], v[196:199], v[24:27], v[144:159]
    ds_read_b64_tr_b16 v[212:213], v217 offset:32768
    ds_read_b64_tr_b16 v[214:215], v217 offset:33280
    ds_read_b128 v[52:55], v237 offset:32768
    s_waitcnt lgkmcnt(7)
    v_mfma_f32_32x32x16_bf16 v[128:143], v[200:203], v[28:31], v[128:143]
    ds_read_b64_tr_b16 v[192:193], v216 offset:34816
    ds_read_b64_tr_b16 v[194:195], v216 offset:35328
    ds_read_b128 v[56:59], v238 offset:32768
    v_mfma_f32_32x32x16_bf16 v[144:159], v[204:207], v[28:31], v[144:159]
    ds_read_b64_tr_b16 v[196:197], v217 offset:34816
    ds_read_b64_tr_b16 v[198:199], v217 offset:35328
    ds_read_b128 v[60:63], v239 offset:32768
    s_waitcnt vmcnt(3)
    s_waitcnt lgkmcnt(0)
    s_barrier
    s_waitcnt vmcnt(2)
    v_readfirstlane_b32 s66, v244
    s_cmp_lg_u32 s60, 0
    s_cbranch_scc1 L_zf16
    s_nop 2
    s_cmp_lg_u32 s66, 0
    s_cbranch_scc1 L_zf16
    v_mov_b32 v250, 0
    s_mov_b32 s78, 0x40000
L_spin17:
    global_load_dword v251, v250, s[56:57] sc1
    s_waitcnt vmcnt(0)
    v_readfirstlane_b32 s66, v251
    s_nop 3
    s_cmp_lg_u32 s66, 0
    s_cbranch_scc1 L_spun17
    s_sleep 8
    s_sub_u32 s78, s78, 1
    s_cbranch_scc0 L_spin17
L_spun17:
L_zf16:
    s_cmp_lg_u32 s60, 0
    s_cbranch_scc1 L_cnt18
    s_add_u32 s66, s63, 0
    s_lshl_b32 s66, s66, 5
    s_add_u32 s66, s66, s64
    s_lshl_b32 s66, s66, 2
    v_mov_b32 v250, s66
    v_mov_b32 v251, 1
    s_mov_b64 s[76:77], exec
    s_mov_b64 exec, 1
    buffer_store_dword v251, v250, s[36:39], 0 offen sc1
    s_mov_b64 exec, s[76:77]
    s_nop 1
L_cnt18:
    s_cmp_lg_u32 s60, 0
    s_cbranch_scc1 L_cnt19
    s_add_u32 s66, s64, 16
    s_lshl_b32 s66, s66, 5
    s_add_u32 s66, s66, s63
    s_lshl_b32 s66, s66, 2
    v_mov_b32 v250, s66
    v_mov_b32 v251, 1
    s_mov_b64 s[76:77], exec
    s_mov_b64 exec, 1
    buffer_store_dword v251, v250, s[36:39], 0 offen sc1
    s_mov_b64 exec, s[76:77]
    s_nop 1
L_cnt19:
    v_mfma_f32_32x32x16_bf16 v[128:143], v[208:211], v[32:35], v[128:143]
    ds_read_b64_tr_b16 v[200:201], v216 offset:36864
    ds_read_b64_tr_b16 v[202:203], v216 offset:37376
    s_lshl_b32 s66, s60, 14
    s_add_u32 s66, s66, 768
    s_lshl_b32 m0, s60, 12
    s_add_u32 m0, m0, 32768
    s_nop 0
    buffer_load_dwordx4 v240, s[16:19], s66 offen lds
    v_mfma_f32_32x32x16_bf16 v[144:159], v[212:215], v[32:35], v[144:159]
    ds_read_b64_tr_b16 v[204:205], v217 offset:36864
    ds_read_b64_tr_b16 v[206:207], v217 offset:37376
    s_lshl_b32 s66, s60, 14
    s_add_u32 s66, s66, 4864
    s_lshl_b32 m0, s60, 12
    s_add_u32 m0, m0, 33792
    s_nop 0
    buffer_load_dwordx4 v241, s[16:19], s66 offen lds
    v_mfma_f32_32x32x16_bf16 v[128:143], v[192:195], v[36:39], v[128:143]
    ds_read_b64_tr_b16 v[208:209], v216 offset:38912
    ds_read_b64_tr_b16 v[210:211], v216 offset:39424
    s_lshl_b32 s66, s60, 14
    s_add_u32 s66, s66, 8960
    s_lshl_b32 m0, s60, 12
    s_add_u32 m0, m0, 34816
    s_nop 0
    buffer_load_dwordx4 v242, s[16:19], s66 offen lds
    v_mfma_f32_32x32x16_bf16 v[144:159], v[196:199], v[36:39], v[144:159]
    ds_read_b64_tr_b16 v[212:213], v217 offset:38912
    ds_read_b64_tr_b16 v[214:215], v217 offset:39424
    s_lshl_b32 s66, s60, 14
    s_add_u32 s66, s66, 13056
    s_lshl_b32 m0, s60, 12
    s_add_u32 m0, m0, 35840
    s_nop 0
    buffer_load_dwordx4 v243, s[16:19], s66 offen lds
    s_waitcnt lgkmcnt(4)
    v_mfma_f32_32x32x16_bf16 v[128:143], v[200:203], v[40:43], v[128:143]
    ds_read_b64_tr_b16 v[192:193], v216 offset:16384
    ds_read_b64_tr_b16 v[194:195], v216 offset:16896
    s_add_u32 s66, s14, 1376256
    s_add_u32 m0, s69, 114688
    s_nop 0
    buffer_load_dwordx4 v218, s[20:23], s66 offen lds
    v_mfma_f32_32x32x16_bf16 v[144:159], v[204:207], v[40:43], v[144:159]
    ds_read_b64_tr_b16 v[196:197], v217 offset:16384
    ds_read_b64_tr_b16 v[198:199], v217 offset:16896
    s_add_u32 s66, s15, 1376256
    s_add_u32 m0, s69, 122880
    s_nop 0
    buffer_load_dwordx4 v219, s[24:27], s66 offen lds
    s_waitcnt lgkmcnt(4)
    v_mfma_f32_32x32x16_bf16 v[128:143], v[208:211], v[44:47], v[128:143]
    ds_read_b64_tr_b16 v[200:201], v216 offset:18432
    ds_read_b64_tr_b16 v[202:203], v216 offset:18944
    v_mfma_f32_32x32x16_bf16 v[144:159], v[212:215], v[44:47], v[144:159]
    ds_read_b64_tr_b16 v[204:205], v217 offset:18432
    ds_read_b64_tr_b16 v[206:207], v217 offset:18944
    s_barrier
    s_mov_b32 s44, s8
    s_mov_b32 s45, s9
    s_mov_b32 s46, 0
    s_mov_b32 s47, 0x20000
    s_mov_b32 s68, 0
    s_cmp_eq_u32 s60, 0
    s_cselect_b32 s44, s8, s44
    s_cselect_b32 s45, s9, s45
    s_mov_b32 s66, 1835008
    s_cselect_b32 s46, s66, s46
    s_mul_i32 s66, s2, 7168
    s_cselect_b32 s68, s66, s68
    s_cmp_eq_u32 s60, 1
    s_cselect_b32 s44, s12, s44
    s_cselect_b32 s45, s13, s45
    s_mov_b32 s66, 524288
    s_cselect_b32 s46, s66, s46
    s_mul_i32 s66, s2, 2048
    s_cselect_b32 s68, s66, s68
    v_lshlrev_b32 v247, 3, v254
    buffer_load_dword v220, v247, s[44:47], s68 offen
    s_waitcnt lgkmcnt(4)
    v_mfma_f32_32x32x16_bf16 v[128:143], v[192:195], v[48:51], v[128:143]
    ds_read_b64_tr_b16 v[208:209], v216 offset:20480
    ds_read_b64_tr_b16 v[210:211], v216 offset:20992
    s_add_u32 s66, s14, 1605632
    s_add_u32 m0, s69, 98304
    s_nop 0
    buffer_load_dwordx4 v218, s[20:23], s66 offen lds
    ds_read_b128 v[64:67], v232 offset:0
    v_mfma_f32_32x32x16_bf16 v[144:159], v[196:199], v[48:51], v[144:159]
    ds_read_b64_tr_b16 v[212:213], v217 offset:20480
    ds_read_b64_tr_b16 v[214:215], v217 offset:20992
    s_add_u32 s66, s15, 1605632
    s_add_u32 m0, s69, 106496
    s_nop 0
    buffer_load_dwordx4 v219, s[24:27], s66 offen lds
    ds_read_b128 v[68:71], v233 offset:0
    s_waitcnt lgkmcnt(6)
    v_mfma_f32_32x32x16_bf16 v[128:143], v[200:203], v[52:55], v[128:143]
    ds_read_b64_tr_b16 v[192:193], v216 offset:22528
    ds_read_b64_tr_b16 v[194:195], v216 offset:23040
    ds_read_b128 v[72:75], v234 offset:0
    v_mfma_f32_32x32x16_bf16 v[144:159], v[204:207], v[52:55], v[144:159]
    ds_read_b64_tr_b16 v[196:197], v217 offset:22528
    ds_read_b64_tr_b16 v[198:199], v217 offset:23040
    ds_read_b128 v[76:79], v235 offset:0
    s_waitcnt lgkmcnt(7)
    v_mfma_f32_32x32x16_bf16 v[128:143], v[208:211], v[56:59], v[128:143]
    ds_read_b64_tr_b16 v[200:201], v216 offset:0
    ds_read_b64_tr_b16 v[202:203], v216 offset:512
    ds_read_b128 v[80:83], v236 offset:0
    v_mfma_f32_32x32x16_bf16 v[144:159], v[212:215], v[56:59], v[144:159]
    ds_read_b64_tr_b16 v[204:205], v217 offset:0
    ds_read_b64_tr_b16 v[206:207], v217 offset:512
    ds_read_b128 v[84:87], v237 offset:0
    s_waitcnt lgkmcnt(7)
    v_mfma_f32_32x32x16_bf16 v[128:143], v[192:195], v[60:63], v[128:143]
    ds_read_b64_tr_b16 v[208:209], v216 offset:2048
    ds_read_b64_tr_b16 v[210:211], v216 offset:2560
    ds_read_b128 v[88:91], v238 offset:0
    v_mfma_f32_32x32x16_bf16 v[144:159], v[196:199], v[60:63], v[144:159]
    ds_read_b64_tr_b16 v[212:213], v217 offset:2048
    ds_read_b64_tr_b16 v[214:215], v217 offset:2560
    ds_read_b128 v[92:95], v239 offset:0
    s_waitcnt vmcnt(9)
    s_waitcnt lgkmcnt(0)
    s_barrier
    v_mfma_f32_32x32x16_bf16 v[128:143], v[200:203], v[64:67], v[128:143]
    ds_read_b64_tr_b16 v[192:193], v216 offset:4096
    ds_read_b64_tr_b16 v[194:195], v216 offset:4608
    s_add_u32 s14, s14, 128
    s_mov_b32 s15, s14
    s_add_u32 s66, s14, 0
    s_add_u32 m0, s69, 0
    s_nop 0
    buffer_load_dwordx4 v218, s[20:23], s66 offen lds
    v_mfma_f32_32x32x16_bf16 v[144:159], v[204:207], v[64:67], v[144:159]
    ds_read_b64_tr_b16 v[196:197], v217 offset:4096
    ds_read_b64_tr_b16 v[198:199], v217 offset:4608
    s_add_u32 s66, s15, 0
    s_add_u32 m0, s69, 8192
    s_nop 0
    buffer_load_dwordx4 v219, s[24:27], s66 offen lds
    v_mfma_f32_32x32x16_bf16 v[128:143], v[208:211], v[68:71], v[128:143]
    ds_read_b64_tr_b16 v[200:201], v216 offset:6144
    ds_read_b64_tr_b16 v[202:203], v216 offset:6656
    v_mfma_f32_32x32x16_bf16 v[144:159], v[212:215], v[68:71], v[144:159]
    ds_read_b64_tr_b16 v[204:205], v217 offset:6144
    ds_read_b64_tr_b16 v[206:207], v217 offset:6656
    s_waitcnt lgkmcnt(4)
    v_mfma_f32_32x32x16_bf16 v[128:143], v[192:195], v[72:75], v[128:143]
    v_add_u32 v216, 0x10000, v216
    v_add_u32 v217, 0x10000, v217
    ds_read_b64_tr_b16 v[208:209], v216 offset:0
    ds_read_b64_tr_b16 v[210:211], v216 offset:512
    v_mfma_f32_32x32x16_bf16 v[144:159], v[196:199], v[72:75], v[144:159]
    ds_read_b64_tr_b16 v[212:213], v217 offset:0
    ds_read_b64_tr_b16 v[214:215], v217 offset:512
    s_waitcnt lgkmcnt(4)
    v_mfma_f32_32x32x16_bf16 v[128:143], v[200:203], v[76:79], v[128:143]
    ds_read_b64_tr_b16 v[192:193], v216 offset:2048
    ds_read_b64_tr_b16 v[194:195], v216 offset:2560
    v_mfma_f32_32x32x16_bf16 v[144:159], v[204:207], v[76:79], v[144:159]
    ds_read_b64_tr_b16 v[196:197], v217 offset:2048
    ds_read_b64_tr_b16 v[198:199], v217 offset:2560
    s_waitcnt vmcnt(5)
    s_barrier
    s_waitcnt lgkmcnt(4)
    v_mfma_f32_32x32x16_bf16 v[128:143], v[208:211], v[80:83], v[128:143]
    ds_read_b64_tr_b16 v[200:201], v216 offset:4096
    ds_read_b64_tr_b16 v[202:203], v216 offset:4608
    s_add_u32 s66, s14, 229376
    s_add_u32 m0, s69, 16384
    s_nop 0
    buffer_load_dwordx4 v218, s[20:23], s66 offen lds
    ds_read_b128 v[96:99], v232 offset:32768
    v_mfma_f32_32x32x16_bf16 v[144:159], v[212:215], v[80:83], v[144:159]
    ds_read_b64_tr_b16 v[204:205], v217 offset:4096
    ds_read_b64_tr_b16 v[206:207], v217 offset:4608
    s_add_u32 s66, s15, 229376
    s_add_u32 m0, s69, 24576
    s_nop 0
    buffer_load_dwordx4 v219, s[24:27], s66 offen lds
    ds_read_b128 v[100:103], v233 offset:32768
    s_waitcnt lgkmcnt(6)
    v_mfma_f32_32x32x16_bf16 v[128:143], v[192:195], v[84:87], v[128:143]
    ds_read_b64_tr_b16 v[208:209], v216 offset:6144
    ds_read_b64_tr_b16 v[210:211], v216 offset:6656
    s_add_u32 s66, s14, 458752
    s_add_u32 m0, s69, 65536
    s_nop 0
    buffer_load_dwordx4 v218, s[20:23], s66 offen lds
    ds_read_b128 v[104:107], v234 offset:32768
    v_mfma_f32_32x32x16_bf16 v[144:159], v[196:199], v[84:87], v[144:159]
    ds_read_b64_tr_b16 v[212:213], v217 offset:6144
    ds_read_b64_tr_b16 v[214:215], v217 offset:6656
    s_add_u32 s66, s15, 458752
    s_add_u32 m0, s69, 73728
    s_nop 0
    buffer_load_dwordx4 v219, s[24:27], s66 offen lds
    ds_read_b128 v[108:111], v235 offset:32768
    s_waitcnt lgkmcnt(7)
    v_mfma_f32_32x32x16_bf16 v[128:143], v[200:203], v[88:91], v[128:143]
    v_add_u32 v216, 0xffff0000, v216
    v_add_u32 v217, 0xffff0000, v217
    ds_read_b64_tr_b16 v[192:193], v216 offset:49152
    ds_read_b64_tr_b16 v[194:195], v216 offset:49664
    ds_read_b128 v[112:115], v236 offset:32768
    v_mfma_f32_32x32x16_bf16 v[144:159], v[204:207], v[88:91], v[144:159]
    ds_read_b64_tr_b16 v[196:197], v217 offset:49152
    ds_read_b64_tr_b16 v[198:199], v217 offset:49664
    ds_read_b128 v[116:119], v237 offset:32768
    s_waitcnt lgkmcnt(7)
    v_mfma_f32_32x32x16_bf16 v[128:143], v[208:211], v[92:95], v[128:143]
    ds_read_b64_tr_b16 v[200:201], v216 offset:51200
    ds_read_b64_tr_b16 v[202:203], v216 offset:51712
    ds_read_b128 v[120:123], v238 offset:32768
    v_mfma_f32_32x32x16_bf16 v[144:159], v[212:215], v[92:95], v[144:159]
    ds_read_b64_tr_b16 v[204:205], v217 offset:51200
    ds_read_b64_tr_b16 v[206:207], v217 offset:51712
    ds_read_b128 v[124:127], v239 offset:32768
    s_waitcnt vmcnt(6)
    s_waitcnt lgkmcnt(0)
    s_barrier
    s_add_u32 s66, s63, 0
    s_lshl_b32 s66, s66, 7
    v_and_b32 v250, 15, v255
    v_lshlrev_b32 v250, 2, v250
    v_add_u32 v250, s66, v250
    buffer_load_dword v245, v250, s[36:39], 0 offen sc1
    s_add_u32 s66, s64, 16
    s_lshl_b32 s66, s66, 7
    v_and_b32 v250, 15, v255
    v_lshlrev_b32 v250, 2, v250
    v_add_u32 v250, s66, v250
    buffer_load_dword v246, v250, s[36:39], 0 offen sc1
    v_mfma_f32_32x32x16_bf16 v[128:143], v[192:195], v[96:99], v[128:143]
    ds_read_b64_tr_b16 v[208:209], v216 offset:53248
    ds_read_b64_tr_b16 v[210:211], v216 offset:53760
    s_add_u32 s66, s14, 688128
    s_add_u32 m0, s69, 32768
    s_nop 0
    buffer_load_dwordx4 v218, s[20:23], s66 offen lds
    v_mfma_f32_32x32x16_bf16 v[144:159], v[196:199], v[96:99], v[144:159]
    ds_read_b64_tr_b16 v[212:213], v217 offset:53248
    ds_read_b64_tr_b16 v[214:215], v217 offset:53760
    s_add_u32 s66, s15, 688128
    s_add_u32 m0, s69, 40960
    s_nop 0
    buffer_load_dwordx4 v219, s[24:27], s66 offen lds
    v_mfma_f32_32x32x16_bf16 v[128:143], v[200:203], v[100:103], v[128:143]
    ds_read_b64_tr_b16 v[192:193], v216 offset:55296
    ds_read_b64_tr_b16 v[194:195], v216 offset:55808
    s_add_u32 s66, s14, 917504
    s_add_u32 m0, s69, 49152
    s_nop 0
    buffer_load_dwordx4 v218, s[20:23], s66 offen lds
    v_mfma_f32_32x32x16_bf16 v[144:159], v[204:207], v[100:103], v[144:159]
    ds_read_b64_tr_b16 v[196:197], v217 offset:55296
    ds_read_b64_tr_b16 v[198:199], v217 offset:55808
    s_add_u32 s66, s15, 917504
    s_add_u32 m0, s69, 57344
    s_nop 0
    buffer_load_dwordx4 v219, s[24:27], s66 offen lds
    s_waitcnt lgkmcnt(4)
    v_mfma_f32_32x32x16_bf16 v[128:143], v[208:211], v[104:107], v[128:143]
    ds_read_b64_tr_b16 v[200:201], v216 offset:32768
    ds_read_b64_tr_b16 v[202:203], v216 offset:33280
    v_mfma_f32_32x32x16_bf16 v[144:159], v[212:215], v[104:107], v[144:159]
    ds_read_b64_tr_b16 v[204:205], v217 offset:32768
    ds_read_b64_tr_b16 v[206:207], v217 offset:33280
    s_waitcnt lgkmcnt(4)
    v_mfma_f32_32x32x16_bf16 v[128:143], v[192:195], v[108:111], v[128:143]
    ds_read_b64_tr_b16 v[208:209], v216 offset:34816
    ds_read_b64_tr_b16 v[210:211], v216 offset:35328
    v_mfma_f32_32x32x16_bf16 v[144:159], v[196:199], v[108:111], v[144:159]
    ds_read_b64_tr_b16 v[212:213], v217 offset:34816
    ds_read_b64_tr_b16 v[214:215], v217 offset:35328
    s_waitcnt vmcnt(10)
    s_barrier
    s_waitcnt lgkmcnt(4)
    v_mfma_f32_32x32x16_bf16 v[128:143], v[200:203], v[112:115], v[128:143]
    ds_read_b64_tr_b16 v[192:193], v216 offset:36864
    ds_read_b64_tr_b16 v[194:195], v216 offset:37376
    v_mfma_f32_32x32x16_bf16 v[144:159], v[204:207], v[112:115], v[144:159]
    ds_read_b64_tr_b16 v[196:197], v217 offset:36864
    ds_read_b64_tr_b16 v[198:199], v217 offset:37376
    s_waitcnt lgkmcnt(4)
    v_mfma_f32_32x32x16_bf16 v[128:143], v[208:211], v[116:119], v[128:143]
    ds_read_b64_tr_b16 v[200:201], v216 offset:38912
    ds_read_b64_tr_b16 v[202:203], v216 offset:39424
    v_mfma_f32_32x32x16_bf16 v[144:159], v[212:215], v[116:119], v[144:159]
    ds_read_b64_tr_b16 v[204:205], v217 offset:38912
    ds_read_b64_tr_b16 v[206:207], v217 offset:39424
    s_waitcnt lgkmcnt(4)
    v_mfma_f32_32x32x16_bf16 v[128:143], v[192:195], v[120:123], v[128:143]
    v_add_u32 v216, 0xffff0000, v216
    v_add_u32 v217, 0xffff0000, v217
    ds_read_b64_tr_b16 v[208:209], v216 offset:0
    ds_read_b64_tr_b16 v[210:211], v216 offset:512
    v_mfma_f32_32x32x16_bf16 v[144:159], v[196:199], v[120:123], v[144:159]
    ds_read_b64_tr_b16 v[212:213], v217 offset:0
    ds_read_b64_tr_b16 v[214:215], v217 offset:512
    s_waitcnt lgkmcnt(4)
    v_mfma_f32_32x32x16_bf16 v[128:143], v[200:203], v[124:127], v[128:143]
    ds_read_b64_tr_b16 v[192:193], v216 offset:2048
    ds_read_b64_tr_b16 v[194:195], v216 offset:2560
    v_mfma_f32_32x32x16_bf16 v[144:159], v[204:207], v[124:127], v[144:159]
    ds_read_b64_tr_b16 v[196:197], v217 offset:2048
    ds_read_b64_tr_b16 v[198:199], v217 offset:2560
    s_waitcnt vmcnt(6)
    s_barrier
    s_waitcnt vmcnt(5)
    v_cmp_ne_u32 vcc, 0, v245
    s_nop 3
    s_and_b32 s66, vcc_lo, 0xffff
    s_cmp_eq_u32 s66, 0xffff
    s_cbranch_scc1 L_pc20
    s_add_u32 s66, s63, 0
    s_lshl_b32 s66, s66, 7
    v_and_b32 v250, 15, v255
    v_lshlrev_b32 v250, 2, v250
    v_add_u32 v250, s66, v250
    s_mov_b32 s78, 0x40000
L_spin21:
    buffer_load_dword v251, v250, s[36:39], 0 offen sc1
    s_waitcnt vmcnt(0)
    v_cmp_ne_u32 vcc, 0, v251
    s_nop 3
    s_and_b32 s66, vcc_lo, 0xffff
    s_cmp_eq_u32 s66, 0xffff
    s_cbranch_scc1 L_spun21
    s_sleep 8
    s_sub_u32 s78, s78, 1
    s_cbranch_scc0 L_spin21
L_spun21:
L_pc20:
    s_waitcnt vmcnt(4)
    v_cmp_ne_u32 vcc, 0, v246
    s_nop 3
    s_and_b32 s66, vcc_lo, 0xffff
    s_cmp_eq_u32 s66, 0xffff
    s_cbranch_scc1 L_pc22
    s_add_u32 s66, s64, 16
    s_lshl_b32 s66, s66, 7
    v_and_b32 v250, 15, v255
    v_lshlrev_b32 v250, 2, v250
    v_add_u32 v250, s66, v250
    s_mov_b32 s78, 0x40000
L_spin23:
    buffer_load_dword v251, v250, s[36:39], 0 offen sc1
    s_waitcnt vmcnt(0)
    v_cmp_ne_u32 vcc, 0, v251
    s_nop 3
    s_and_b32 s66, vcc_lo, 0xffff
    s_cmp_eq_u32 s66, 0xffff
    s_cbranch_scc1 L_spun23
    s_sleep 8
    s_sub_u32 s78, s78, 1
    s_cbranch_scc0 L_spin23
L_spun23:
L_pc22:
    v_lshlrev_b32 v225, 3, v255
    v_mov_b32 v224, 0x7ff00000
    v_cmp_gt_u32 vcc, 128, v255
    s_nop 1
    v_cndmask_b32 v225, v224, v225, vcc
    s_lshl_b32 s68, s63, 10
    s_add_u32 s68, s68, 65536
    buffer_load_dwordx2 v[220:221], v225, s[36:39], s68 offen sc1
    v_lshlrev_b32 v223, 2, v255
    v_cmp_gt_u32 vcc, 320, v255
    s_nop 1
    v_cndmask_b32 v223, v224, v223, vcc
    s_mul_i32 s3, s64, 20480
    s_add_u32 s3, s3, 131072
    s_waitcnt lgkmcnt(4)
    v_mfma_f32_32x32x16_bf16 v[160:175], v[208:211], v[0:3], 0
    ds_read_b64_tr_b16 v[200:201], v216 offset:4096
    ds_read_b64_tr_b16 v[202:203], v216 offset:4608
    s_add_u32 s66, s14, 1146880
    s_add_u32 m0, s69, 81920
    s_nop 0
    buffer_load_dwordx4 v218, s[20:23], s66 offen lds
    s_add_u32 s68, s3, 0
    buffer_load_dword v232, v223, s[36:39], s68 offen sc1
    s_add_u32 s68, s3, 1280
    buffer_load_dword v233, v223, s[36:39], s68 offen sc1
    v_mfma_f32_32x32x16_bf16 v[176:191], v[212:215], v[0:3], 0
    ds_read_b64_tr_b16 v[204:205], v217 offset:4096
    ds_read_b64_tr_b16 v[206:207], v217 offset:4608
    s_add_u32 s66, s15, 1146880
    s_add_u32 m0, s69, 90112
    s_nop 0
    buffer_load_dwordx4 v219, s[24:27], s66 offen lds
    s_add_u32 s68, s3, 2560
    buffer_load_dword v234, v223, s[36:39], s68 offen sc1
    s_add_u32 s68, s3, 3840
    buffer_load_dword v235, v223, s[36:39], s68 offen sc1
    s_waitcnt lgkmcnt(4)
    v_mfma_f32_32x32x16_bf16 v[160:175], v[192:195], v[4:7], v[160:175]
    ds_read_b64_tr_b16 v[208:209], v216 offset:6144
    ds_read_b64_tr_b16 v[210:211], v216 offset:6656
    s_add_u32 s66, s14, 1376256
    s_add_u32 m0, s69, 98304
    s_nop 0
    buffer_load_dwordx4 v218, s[20:23], s66 offen lds
    s_add_u32 s68, s3, 5120
    buffer_load_dword v236, v223, s[36:39], s68 offen sc1
    s_add_u32 s68, s3, 6400
    buffer_load_dword v237, v223, s[36:39], s68 offen sc1
    v_mfma_f32_32x32x16_bf16 v[176:191], v[196:199], v[4:7], v[176:191]
    ds_read_b64_tr_b16 v[212:213], v217 offset:6144
    ds_read_b64_tr_b16 v[214:215], v217 offset:6656
    s_add_u32 s66, s15, 1376256
    s_add_u32 m0, s69, 106496
    s_nop 0
    buffer_load_dwordx4 v219, s[24:27], s66 offen lds
    s_add_u32 s68, s3, 7680
    buffer_load_dword v238, v223, s[36:39], s68 offen sc1
    s_add_u32 s68, s3, 8960
    buffer_load_dword v239, v223, s[36:39], s68 offen sc1
    s_waitcnt lgkmcnt(4)
    v_mfma_f32_32x32x16_bf16 v[160:175], v[200:203], v[8:11], v[160:175]
    ds_read_b64_tr_b16 v[192:193], v216 offset:16384
    ds_read_b64_tr_b16 v[194:195], v216 offset:16896
    s_add_u32 s68, s3, 10240
    buffer_load_dword v240, v223, s[36:39], s68 offen sc1
    s_add_u32 s68, s3, 11520
    buffer_load_dword v241, v223, s[36:39], s68 offen sc1
    v_mfma_f32_32x32x16_bf16 v[176:191], v[204:207], v[8:11], v[176:191]
    ds_read_b64_tr_b16 v[196:197], v217 offset:16384
    ds_read_b64_tr_b16 v[198:199], v217 offset:16896
    s_add_u32 s68, s3, 12800
    buffer_load_dword v242, v223, s[36:39], s68 offen sc1
    s_add_u32 s68, s3, 14080
    buffer_load_dword v243, v223, s[36:39], s68 offen sc1
    s_waitcnt lgkmcnt(4)
    v_mfma_f32_32x32x16_bf16 v[160:175], v[208:211], v[12:15], v[160:175]
    ds_read_b64_tr_b16 v[200:201], v216 offset:18432
    ds_read_b64_tr_b16 v[202:203], v216 offset:18944
    s_add_u32 s68, s3, 15360
    buffer_load_dword v244, v223, s[36:39], s68 offen sc1
    s_add_u32 s68, s3, 16640
    buffer_load_dword v245, v223, s[36:39], s68 offen sc1
    v_mfma_f32_32x32x16_bf16 v[176:191], v[212:215], v[12:15], v[176:191]
    ds_read_b64_tr_b16 v[204:205], v217 offset:18432
    ds_read_b64_tr_b16 v[206:207], v217 offset:18944
    s_add_u32 s68, s3, 17920
    buffer_load_dword v246, v223, s[36:39], s68 offen sc1
    s_add_u32 s68, s3, 19200
    buffer_load_dword v222, v223, s[36:39], s68 offen sc1
    s_waitcnt lgkmcnt(4)
    v_mfma_f32_32x32x16_bf16 v[160:175], v[192:195], v[16:19], v[160:175]
    ds_read_b64_tr_b16 v[208:209], v216 offset:20480
    ds_read_b64_tr_b16 v[210:211], v216 offset:20992
    v_mfma_f32_32x32x16_bf16 v[176:191], v[196:199], v[16:19], v[176:191]
    ds_read_b64_tr_b16 v[212:213], v217 offset:20480
    ds_read_b64_tr_b16 v[214:215], v217 offset:20992
    s_waitcnt lgkmcnt(4)
    v_mfma_f32_32x32x16_bf16 v[160:175], v[200:203], v[20:23], v[160:175]
    ds_read_b64_tr_b16 v[192:193], v216 offset:22528
    ds_read_b64_tr_b16 v[194:195], v216 offset:23040
    v_mfma_f32_32x32x16_bf16 v[176:191], v[204:207], v[20:23], v[176:191]
    ds_read_b64_tr_b16 v[196:197], v217 offset:22528
    ds_read_b64_tr_b16 v[198:199], v217 offset:23040
    s_waitcnt vmcnt(17)
    v_add_f32 v232, v232, v233
    s_waitcnt vmcnt(14)
    v_add_f32 v234, v234, v235
    s_waitcnt vmcnt(11)
    v_add_f32 v236, v236, v237
    s_waitcnt vmcnt(8)
    v_add_f32 v238, v238, v239
    s_waitcnt vmcnt(6)
    v_add_f32 v240, v240, v241
    s_waitcnt vmcnt(4)
    v_add_f32 v242, v242, v243
    s_waitcnt vmcnt(2)
    v_add_f32 v244, v244, v245
    s_waitcnt vmcnt(0)
    v_add_f32 v246, v246, v222
    v_add_f32 v232, v232, v234
    v_add_f32 v236, v236, v238
    v_add_f32 v240, v240, v242
    v_add_f32 v244, v244, v246
    v_add_f32 v232, v232, v236
    v_add_f32 v240, v240, v244
    v_add_f32 v232, v232, v240
    v_lshlrev_b32 v223, 2, v255
    v_add_u32 v224, 0x24000, v223
    v_add_u32 v225, 0x24c00, v223
    v_mov_b32 v223, 0
    v_cmp_gt_u32 vcc, 320, v255
    s_nop 1
    s_and_saveexec_b64 s[76:77], vcc
    ds_write_b32 v224, v232
    s_mov_b64 exec, s[76:77]
    v_cmp_gt_u32 vcc, 384, v255
    s_nop 1
    s_and_saveexec_b64 s[76:77], vcc
    ds_write_b32 v224, v223 offset:1536
    s_mov_b64 exec, s[76:77]
    v_cmp_gt_u32 vcc, 128, v255
    s_nop 1
    s_and_saveexec_b64 s[76:77], vcc
    ds_write_b32 v225, v221
    ds_write_b32 v225, v220 offset:512
    s_mov_b64 exec, s[76:77]
    s_waitcnt lgkmcnt(8)
    v_mfma_f32_32x32x16_bf16 v[160:175], v[208:211], v[24:27], v[160:175]
    v_add_u32 v216, 0x10000, v216
    v_add_u32 v217, 0x10000, v217
    ds_read_b64_tr_b16 v[200:201], v216 offset:0
    ds_read_b64_tr_b16 v[202:203], v216 offset:512
    v_mfma_f32_32x32x16_bf16 v[176:191], v[212:215], v[24:27], v[176:191]
    ds_read_b64_tr_b16 v[204:205], v217 offset:0
    ds_read_b64_tr_b16 v[206:207], v217 offset:512
    s_waitcnt lgkmcnt(8)
    v_mfma_f32_32x32x16_bf16 v[160:175], v[192:195], v[28:31], v[160:175]
    ds_read_b64_tr_b16 v[208:209], v216 offset:2048
    ds_read_b64_tr_b16 v[210:211], v216 offset:2560
    v_mfma_f32_32x32x16_bf16 v[176:191], v[196:199], v[28:31], v[176:191]
    ds_read_b64_tr_b16 v[212:213], v217 offset:2048
    ds_read_b64_tr_b16 v[214:215], v217 offset:2560
    s_waitcnt lgkmcnt(0)
    s_barrier
    v_and_b32 v232, 31, v255
    s_lshl_b32 s66, s61, 5
    v_add_u32 v232, s66, v232
    v_lshlrev_b32 v232, 2, v232
    v_add_u32 v232, 0x24c00, v232
    ds_read_b32 v223, v232
    ds_read_b32 v233, v232 offset:512
    s_waitcnt lgkmcnt(1)
    v_mul_f32 v220, s72, v223
    v_mul_f32 v222, v223, v223
    v_mul_f32 v221, v220, v222
    v_mul_f32 v221, 0x3d372713, v221
    v_rcp_f32 v222, v222
    s_waitcnt lgkmcnt(0)
    v_cvt_pk_bf16_f32 v234, v233, v233
    v_lshlrev_b32 v235, 16, v234
    v_sub_f32 v235, v233, v235
    v_cvt_pk_bf16_f32 v228, v233, v235
    v_cvt_pk_bf16_f32 v229, v233, 0
    v_mov_b32 v234, 0
    s_mov_b32 s100, 0
    s_mov_b32 s101, -1
    v_cndmask_b32 v228, v228, v234, s[100:101]
    v_cndmask_b32 v229, v229, v234, s[100:101]
    v_mfma_f32_32x32x16_bf16 v[160:175], v[200:203], v[32:35], v[160:175]
    ds_read_b64_tr_b16 v[192:193], v216 offset:4096
    ds_read_b64_tr_b16 v[194:195], v216 offset:4608
    s_add_u32 s66, s14, 1605632
    s_add_u32 m0, s69, 0
    s_nop 0
    buffer_load_dwordx4 v218, s[20:23], s66 offen lds
    s_lshl_b32 s3, s65, 3
    s_lshl_b32 s67, s62, 1
    s_add_u32 s3, s3, s67
    s_lshl_b32 s3, s3, 10
    v_bfe_u32 v248, v255, 4, 1
    v_lshlrev_b32 v248, 8, v248
    v_and_b32 v249, 15, v255
    v_mfma_f32_32x32x16_bf16 v[176:191], v[204:207], v[32:35], v[176:191]
    ds_read_b64_tr_b16 v[196:197], v217 offset:4096
    ds_read_b64_tr_b16 v[198:199], v217 offset:4608
    s_add_u32 s66, s15, 1605632
    s_add_u32 m0, s69, 8192
    s_nop 0
    buffer_load_dwordx4 v219, s[24:27], s66 offen lds
    v_lshl_add_u32 v248, v249, 2, v248
    s_lshl_b32 s67, s62, 7
    s_add_u32 s67, s67, 147456
    v_add_u32 v252, s67, v248
    v_mov_b32 v248, 0x24600
    s_mov_b32 s100, 0
    s_mov_b32 s101, -1
    v_cndmask_b32 v252, v252, v248, s[100:101]
    v_mfma_f32_32x32x16_bf16 v[160:175], v[208:211], v[36:39], v[160:175]
    ds_read_b64_tr_b16 v[200:201], v216 offset:6144
    ds_read_b64_tr_b16 v[202:203], v216 offset:6656
    v_and_b32 v247, 63, v255
    v_lshrrev_b32 v248, 3, v247
    v_mul_u32_u24 v218, 3072, v248
    v_and_b32 v248, 7, v247
    v_bfe_u32 v249, v247, 4, 1
    v_lshlrev_b32 v249, 2, v249
    v_xor_b32 v248, v248, v249
    v_lshl_add_u32 v218, v248, 4, v218
    v_mov_b32 v219, v218
    s_mov_b32 s20, s6
    s_mov_b32 s21, s7
    s_mov_b32 s22, 1572864
    s_mov_b32 s23, 0x20000
    s_mov_b32 s24, s6
    s_mov_b32 s25, s7
    s_mov_b32 s26, 1572864
    s_mov_b32 s27, 0x20000
    s_lshl_b32 s14, s65, 7
    s_mul_i32 s66, s60, 24576
    s_add_u32 s14, s14, s66
    s_add_u32 s15, s14, 196608
    s_add_u32 s66, s14, 0
    s_add_u32 m0, s69, 16384
    s_nop 0
    buffer_load_dwordx4 v218, s[20:23], s66 offen lds
    ds_read_b32 v240, v252 offset:0
    v_mfma_f32_32x32x16_bf16 v[176:191], v[212:215], v[36:39], v[176:191]
    ds_read_b64_tr_b16 v[204:205], v217 offset:6144
    ds_read_b64_tr_b16 v[206:207], v217 offset:6656
    s_add_u32 s66, s15, 0
    s_add_u32 m0, s69, 24576
    s_nop 0
    buffer_load_dwordx4 v219, s[24:27], s66 offen lds
    ds_read_b32 v242, v252 offset:64
    s_waitcnt lgkmcnt(6)
    v_mfma_f32_32x32x16_bf16 v[160:175], v[192:195], v[40:43], v[160:175]
    v_add_u32 v216, 0xffff0000, v216
    v_add_u32 v217, 0xffff0000, v217
    ds_read_b64_tr_b16 v[208:209], v216 offset:32768
    ds_read_b64_tr_b16 v[210:211], v216 offset:33280
    v_mfma_f32_32x32x16_bf16 v[176:191], v[196:199], v[40:43], v[176:191]
    ds_read_b64_tr_b16 v[212:213], v217 offset:32768
    ds_read_b64_tr_b16 v[214:215], v217 offset:33280
    s_waitcnt lgkmcnt(5)
    v_mfma_f32_32x32x16_bf16 v[160:175], v[200:203], v[44:47], v[160:175]
    ds_read_b64_tr_b16 v[192:193], v216 offset:34816
    ds_read_b64_tr_b16 v[194:195], v216 offset:35328
    v_cvt_pk_bf16_f32 v224, v240, v240
    v_lshlrev_b32 v241, 16, v224
    v_sub_f32 v241, v240, v241
    v_cvt_pk_bf16_f32 v225, v241, 0
    v_mfma_f32_32x32x16_bf16 v[176:191], v[204:207], v[44:47], v[176:191]
    ds_read_b64_tr_b16 v[196:197], v217 offset:34816
    ds_read_b64_tr_b16 v[198:199], v217 offset:35328
    v_mfma_f32_32x32x16_bf16 v[128:143], v[224:227], v[228:231], v[128:143]
    s_waitcnt lgkmcnt(8)
    v_cvt_pk_bf16_f32 v224, v242, v242
    v_lshlrev_b32 v243, 16, v224
    v_sub_f32 v243, v242, v243
    s_waitcnt lgkmcnt(4)
    v_mfma_f32_32x32x16_bf16 v[160:175], v[208:211], v[48:51], v[160:175]
    ds_read_b64_tr_b16 v[200:201], v216 offset:36864
    ds_read_b64_tr_b16 v[202:203], v216 offset:37376
    v_cvt_pk_bf16_f32 v225, v243, 0
    v_mfma_f32_32x32x16_bf16 v[176:191], v[212:215], v[48:51], v[176:191]
    ds_read_b64_tr_b16 v[204:205], v217 offset:36864
    ds_read_b64_tr_b16 v[206:207], v217 offset:37376
    v_mfma_f32_32x32x16_bf16 v[144:159], v[224:227], v[228:231], v[144:159]
    s_waitcnt lgkmcnt(4)
    v_mfma_f32_32x32x16_bf16 v[160:175], v[192:195], v[52:55], v[160:175]
    ds_read_b64_tr_b16 v[208:209], v216 offset:38912
    ds_read_b64_tr_b16 v[210:211], v216 offset:39424
    v_mfma_f32_32x32x16_bf16 v[176:191], v[196:199], v[52:55], v[176:191]
    ds_read_b64_tr_b16 v[212:213], v217 offset:38912
    ds_read_b64_tr_b16 v[214:215], v217 offset:39424
    s_waitcnt lgkmcnt(4)
    v_mfma_f32_32x32x16_bf16 v[160:175], v[200:203], v[56:59], v[160:175]
    ds_read_b64_tr_b16 v[192:193], v216 offset:49152
    ds_read_b64_tr_b16 v[194:195], v216 offset:49664
    v_mul_f32 v232, v128, v128
    v_mul_f32 v233, v129, v129
    v_mul_f32 v234, v130, v130
    v_mul_f32 v235, v131, v131
    v_mfma_f32_32x32x16_bf16 v[176:191], v[204:207], v[56:59], v[176:191]
    ds_read_b64_tr_b16 v[196:197], v217 offset:49152
    ds_read_b64_tr_b16 v[198:199], v217 offset:49664
    v_mul_f32 v236, v132, v132
    v_mul_f32 v237, v133, v133
    v_mul_f32 v238, v134, v134
    v_mul_f32 v239, v135, v135
    s_waitcnt lgkmcnt(4)
    v_mfma_f32_32x32x16_bf16 v[160:175], v[208:211], v[60:63], v[160:175]
    ds_read_b64_tr_b16 v[200:201], v216 offset:51200
    ds_read_b64_tr_b16 v[202:203], v216 offset:51712
    v_fma_f32 v232, v232, v221, v220
    v_fma_f32 v233, v233, v221, v220
    v_fma_f32 v234, v234, v221, v220
    v_fma_f32 v235, v235, v221, v220
    v_mfma_f32_32x32x16_bf16 v[176:191], v[212:215], v[60:63], v[176:191]
    ds_read_b64_tr_b16 v[204:205], v217 offset:51200
    ds_read_b64_tr_b16 v[206:207], v217 offset:51712
    v_fma_f32 v236, v236, v221, v220
    v_fma_f32 v237, v237, v221, v220
    v_fma_f32 v238, v238, v221, v220
    v_fma_f32 v239, v239, v221, v220
    s_barrier
    s_waitcnt lgkmcnt(4)
    v_mfma_f32_32x32x16_bf16 v[160:175], v[192:195], v[64:67], v[160:175]
    ds_read_b64_tr_b16 v[208:209], v216 offset:53248
    ds_read_b64_tr_b16 v[210:211], v216 offset:53760
    s_add_u32 s66, s14, 393216
    s_add_u32 m0, s69, 32768
    s_nop 0
    buffer_load_dwordx4 v218, s[20:23], s66 offen lds
    v_mul_f32 v232, v232, v128
    v_mul_f32 v233, v233, v129
    v_mul_f32 v234, v234, v130
    v_mul_f32 v235, v235, v131
    v_mfma_f32_32x32x16_bf16 v[176:191], v[196:199], v[64:67], v[176:191]
    ds_read_b64_tr_b16 v[212:213], v217 offset:53248
    ds_read_b64_tr_b16 v[214:215], v217 offset:53760
    s_add_u32 s66, s15, 393216
    s_add_u32 m0, s69, 40960
    s_nop 0
    buffer_load_dwordx4 v219, s[24:27], s66 offen lds
    v_mul_f32 v236, v236, v132
    v_mul_f32 v237, v237, v133
    v_mul_f32 v238, v238, v134
    v_mul_f32 v239, v239, v135
    v_exp_f32 v232, v232
    s_waitcnt lgkmcnt(4)
    v_mfma_f32_32x32x16_bf16 v[160:175], v[200:203], v[68:71], v[160:175]
    ds_read_b64_tr_b16 v[192:193], v216 offset:55296
    ds_read_b64_tr_b16 v[194:195], v216 offset:55808
    s_add_u32 s66, s14, 786432
    s_add_u32 m0, s69, 65536
    s_nop 0
    buffer_load_dwordx4 v218, s[20:23], s66 offen lds
    v_exp_f32 v233, v233
    v_exp_f32 v234, v234
    v_exp_f32 v235, v235
    v_exp_f32 v236, v236
    v_mfma_f32_32x32x16_bf16 v[176:191], v[204:207], v[68:71], v[176:191]
    ds_read_b64_tr_b16 v[196:197], v217 offset:55296
    ds_read_b64_tr_b16 v[198:199], v217 offset:55808
    s_add_u32 s66, s15, 786432
    s_add_u32 m0, s69, 73728
    s_nop 0
    buffer_load_dwordx4 v219, s[24:27], s66 offen lds
    v_exp_f32 v237, v237
    v_exp_f32 v238, v238
    v_exp_f32 v239, v239
    v_mul_f32 v128, v128, v136
    s_waitcnt lgkmcnt(4)
    v_mfma_f32_32x32x16_bf16 v[160:175], v[208:211], v[72:75], v[160:175]
    v_add_u32 v216, 0x10000, v216
    v_add_u32 v217, 0x10000, v217
    ds_read_b64_tr_b16 v[200:201], v216 offset:16384
    ds_read_b64_tr_b16 v[202:203], v216 offset:16896
    v_and_b32 v247, 63, v255
    v_lshrrev_b32 v248, 3, v247
    v_lshlrev_b32 v253, 10, v248
    v_and_b32 v248, 7, v247
    v_bfe_u32 v249, v247, 4, 1
    v_lshlrev_b32 v249, 2, v249
    v_xor_b32 v248, v248, v249
    v_lshl_add_u32 v253, v248, 4, v253
    s_lshl_b32 s66, s75, 7
    v_add_u32 v253, s66, v253
    s_mov_b32 s40, s8
    s_mov_b32 s41, s9
    s_mov_b32 s42, 1835008
    s_mov_b32 s43, 0x20000
    s_mov_b32 s44, s12
    s_mov_b32 s45, s13
    s_mov_b32 s46, 524288
    s_mov_b32 s47, 0x20000
    s_mul_i32 s50, s48, 28
    s_add_u32 s50, s50, s49
    s_lshl_b32 s50, s50, 14
    s_lshl_b32 s51, s48, 3
    s_add_u32 s51, s51, s49
    s_lshl_b32 s51, s51, 14
    s_lshl_b32 s73, s48, 12
    s_lshl_b32 s66, s49, 11
    s_add_u32 s73, s73, s66
    s_add_u32 s66, s50, 0
    s_add_u32 m0, s73, 114688
    s_nop 0
    buffer_load_dwordx4 v253, s[40:43], s66 offen lds
    v_mul_f32 v129, v129, v137
    v_mul_f32 v130, v130, v138
    v_mul_f32 v131, v131, v139
    v_mul_f32 v132, v132, v140
    v_mfma_f32_32x32x16_bf16 v[176:191], v[212:215], v[72:75], v[176:191]
    ds_read_b64_tr_b16 v[204:205], v217 offset:16384
    ds_read_b64_tr_b16 v[206:207], v217 offset:16896
    s_add_u32 s66, s50, 8192
    s_add_u32 m0, s73, 115712
    s_nop 0
    buffer_load_dwordx4 v253, s[40:43], s66 offen lds
    v_mul_f32 v133, v133, v141
    v_mul_f32 v134, v134, v142
    v_mul_f32 v135, v135, v143
    v_fma_f32 v232, v232, v222, v222
    v_fma_f32 v233, v233, v222, v222
    s_waitcnt lgkmcnt(4)
    v_mfma_f32_32x32x16_bf16 v[160:175], v[192:195], v[76:79], v[160:175]
    ds_read_b64_tr_b16 v[208:209], v216 offset:18432
    ds_read_b64_tr_b16 v[210:211], v216 offset:18944
    v_fma_f32 v234, v234, v222, v222
    v_fma_f32 v235, v235, v222, v222
    v_fma_f32 v236, v236, v222, v222
    v_fma_f32 v237, v237, v222, v222
    v_mfma_f32_32x32x16_bf16 v[176:191], v[196:199], v[76:79], v[176:191]
    ds_read_b64_tr_b16 v[212:213], v217 offset:18432
    ds_read_b64_tr_b16 v[214:215], v217 offset:18944
    v_fma_f32 v238, v238, v222, v222
    v_fma_f32 v239, v239, v222, v222
    v_rcp_f32 v232, v232
    v_rcp_f32 v233, v233
    s_waitcnt lgkmcnt(4)
    v_mfma_f32_32x32x16_bf16 v[160:175], v[200:203], v[80:83], v[160:175]
    ds_read_b64_tr_b16 v[192:193], v216 offset:20480
    ds_read_b64_tr_b16 v[194:195], v216 offset:20992
    v_rcp_f32 v234, v234
    v_rcp_f32 v235, v235
    v_rcp_f32 v236, v236
    v_rcp_f32 v237, v237
    v_mfma_f32_32x32x16_bf16 v[176:191], v[204:207], v[80:83], v[176:191]
    ds_read_b64_tr_b16 v[196:197], v217 offset:20480
    ds_read_b64_tr_b16 v[198:199], v217 offset:20992
    v_rcp_f32 v238, v238
    v_rcp_f32 v239, v239
    v_mul_f32 v128, v128, v232
    v_mul_f32 v129, v129, v233
    s_waitcnt lgkmcnt(4)
    v_mfma_f32_32x32x16_bf16 v[160:175], v[208:211], v[84:87], v[160:175]
    ds_read_b64_tr_b16 v[200:201], v216 offset:22528
    ds_read_b64_tr_b16 v[202:203], v216 offset:23040
    v_mul_f32 v130, v130, v234
    v_mul_f32 v131, v131, v235
    v_mul_f32 v132, v132, v236
    v_mul_f32 v133, v133, v237
    v_mfma_f32_32x32x16_bf16 v[176:191], v[212:215], v[84:87], v[176:191]
    ds_read_b64_tr_b16 v[204:205], v217 offset:22528
    ds_read_b64_tr_b16 v[206:207], v217 offset:23040
    v_mul_f32 v134, v134, v238
    v_mul_f32 v135, v135, v239
    v_cvt_pk_bf16_f32 v136, v128, v129
    v_cvt_pk_bf16_f32 v137, v130, v131
    v_cvt_pk_bf16_f32 v138, v132, v133
    s_waitcnt lgkmcnt(4)
    v_mfma_f32_32x32x16_bf16 v[160:175], v[192:195], v[88:91], v[160:175]
    ds_read_b64_tr_b16 v[208:209], v216 offset:32768
    ds_read_b64_tr_b16 v[210:211], v216 offset:33280
    v_cvt_pk_bf16_f32 v139, v134, v135
    s_add_u32 s67, s3, 0
    buffer_store_dwordx4 v[136:139], v254, s[28:31], s67 offen sc1
    v_mul_f32 v232, v144, v144
    v_mul_f32 v233, v145, v145
    v_mfma_f32_32x32x16_bf16 v[176:191], v[196:199], v[88:91], v[176:191]
    ds_read_b64_tr_b16 v[212:213], v217 offset:32768
    ds_read_b64_tr_b16 v[214:215], v217 offset:33280
    v_mul_f32 v234, v146, v146
    v_mul_f32 v235, v147, v147
    v_mul_f32 v236, v148, v148
    v_mul_f32 v237, v149, v149
    s_waitcnt lgkmcnt(4)
    v_mfma_f32_32x32x16_bf16 v[160:175], v[200:203], v[92:95], v[160:175]
    ds_read_b64_tr_b16 v[192:193], v216 offset:34816
    ds_read_b64_tr_b16 v[194:195], v216 offset:35328
    v_mul_f32 v238, v150, v150
    v_mul_f32 v239, v151, v151
    v_fma_f32 v232, v232, v221, v220
    v_fma_f32 v233, v233, v221, v220
    v_mfma_f32_32x32x16_bf16 v[176:191], v[204:207], v[92:95], v[176:191]
    ds_read_b64_tr_b16 v[196:197], v217 offset:34816
    ds_read_b64_tr_b16 v[198:199], v217 offset:35328
    v_fma_f32 v234, v234, v221, v220
    v_fma_f32 v235, v235, v221, v220
    v_fma_f32 v236, v236, v221, v220
    v_fma_f32 v237, v237, v221, v220
    v_fma_f32 v238, v238, v221, v220
    s_waitcnt vmcnt(7)
    s_barrier
    s_waitcnt lgkmcnt(4)
    v_mfma_f32_32x32x16_bf16 v[160:175], v[208:211], v[96:99], v[160:175]
    ds_read_b64_tr_b16 v[200:201], v216 offset:36864
    ds_read_b64_tr_b16 v[202:203], v216 offset:37376
    s_add_u32 s66, s14, 1179648
    s_add_u32 m0, s69, 49152
    s_nop 0
    buffer_load_dwordx4 v218, s[20:23], s66 offen lds
    v_fma_f32 v239, v239, v221, v220
    v_mul_f32 v232, v232, v144
    v_mul_f32 v233, v233, v145
    v_mul_f32 v234, v234, v146
    v_mfma_f32_32x32x16_bf16 v[176:191], v[212:215], v[96:99], v[176:191]
    ds_read_b64_tr_b16 v[204:205], v217 offset:36864
    ds_read_b64_tr_b16 v[206:207], v217 offset:37376
    s_add_u32 s66, s15, 1179648
    s_add_u32 m0, s69, 57344
    s_nop 0
    buffer_load_dwordx4 v219, s[24:27], s66 offen lds
    v_mul_f32 v235, v235, v147
    v_mul_f32 v236, v236, v148
    v_mul_f32 v237, v237, v149
    v_mul_f32 v238, v238, v150
    s_waitcnt lgkmcnt(4)
    v_mfma_f32_32x32x16_bf16 v[160:175], v[192:195], v[100:103], v[160:175]
    ds_read_b64_tr_b16 v[208:209], v216 offset:38912
    ds_read_b64_tr_b16 v[210:211], v216 offset:39424
    s_add_u32 s66, s50, 32768
    s_add_u32 m0, s73, 81920
    s_nop 0
    buffer_load_dwordx4 v253, s[40:43], s66 offen lds
    v_mul_f32 v239, v239, v151
    v_exp_f32 v232, v232
    v_exp_f32 v233, v233
    v_exp_f32 v234, v234
    v_mfma_f32_32x32x16_bf16 v[176:191], v[196:199], v[100:103], v[176:191]
    ds_read_b64_tr_b16 v[212:213], v217 offset:38912
    ds_read_b64_tr_b16 v[214:215], v217 offset:39424
    s_add_u32 s66, s50, 40960
    s_add_u32 m0, s73, 82944
    s_nop 0
    buffer_load_dwordx4 v253, s[40:43], s66 offen lds
    v_exp_f32 v235, v235
    v_exp_f32 v236, v236
    v_exp_f32 v237, v237
    v_exp_f32 v238, v238
    v_exp_f32 v239, v239
    s_waitcnt lgkmcnt(4)
    v_mfma_f32_32x32x16_bf16 v[160:175], v[200:203], v[104:107], v[160:175]
    v_add_u32 v216, 0xffff0000, v216
    v_add_u32 v217, 0xffff0000, v217
    ds_read_b64_tr_b16 v[192:193], v216 offset:0
    ds_read_b64_tr_b16 v[194:195], v216 offset:512
    s_add_u32 s66, s50, 65536
    s_add_u32 m0, s73, 131072
    s_nop 0
    buffer_load_dwordx4 v253, s[40:43], s66 offen lds
    v_mul_f32 v144, v144, v152
    v_mul_f32 v145, v145, v153
    v_mul_f32 v146, v146, v154
    v_mul_f32 v147, v147, v155
    v_mfma_f32_32x32x16_bf16 v[176:191], v[204:207], v[104:107], v[176:191]
    ds_read_b64_tr_b16 v[196:197], v217 offset:0
    ds_read_b64_tr_b16 v[198:199], v217 offset:512
    s_add_u32 s66, s50, 73728
    s_add_u32 m0, s73, 132096
    s_nop 0
    buffer_load_dwordx4 v253, s[40:43], s66 offen lds
    v_mul_f32 v148, v148, v156
    v_mul_f32 v149, v149, v157
    v_mul_f32 v150, v150, v158
    v_mul_f32 v151, v151, v159
    s_waitcnt lgkmcnt(4)
    v_mfma_f32_32x32x16_bf16 v[160:175], v[208:211], v[108:111], v[160:175]
    ds_read_b64_tr_b16 v[200:201], v216 offset:2048
    ds_read_b64_tr_b16 v[202:203], v216 offset:2560
    v_fma_f32 v232, v232, v222, v222
    v_fma_f32 v233, v233, v222, v222
    v_fma_f32 v234, v234, v222, v222
    v_fma_f32 v235, v235, v222, v222
    v_mfma_f32_32x32x16_bf16 v[176:191], v[212:215], v[108:111], v[176:191]
    ds_read_b64_tr_b16 v[204:205], v217 offset:2048
    ds_read_b64_tr_b16 v[206:207], v217 offset:2560
    v_fma_f32 v236, v236, v222, v222
    v_fma_f32 v237, v237, v222, v222
    v_fma_f32 v238, v238, v222, v222
    v_fma_f32 v239, v239, v222, v222
    s_waitcnt lgkmcnt(4)
    v_mfma_f32_32x32x16_bf16 v[160:175], v[192:195], v[112:115], v[160:175]
    ds_read_b64_tr_b16 v[208:209], v216 offset:4096
    ds_read_b64_tr_b16 v[210:211], v216 offset:4608
    v_rcp_f32 v232, v232
    v_rcp_f32 v233, v233
    v_rcp_f32 v234, v234
    v_rcp_f32 v235, v235
    v_mfma_f32_32x32x16_bf16 v[176:191], v[196:199], v[112:115], v[176:191]
    ds_read_b64_tr_b16 v[212:213], v217 offset:4096
    ds_read_b64_tr_b16 v[214:215], v217 offset:4608
    v_rcp_f32 v236, v236
    v_rcp_f32 v237, v237
    v_rcp_f32 v238, v238
    v_rcp_f32 v239, v239
    v_mul_f32 v144, v144, v232
    s_waitcnt lgkmcnt(4)
    v_mfma_f32_32x32x16_bf16 v[160:175], v[200:203], v[116:119], v[160:175]
    ds_read_b64_tr_b16 v[192:193], v216 offset:6144
    ds_read_b64_tr_b16 v[194:195], v216 offset:6656
    v_mul_f32 v145, v145, v233
    v_mul_f32 v146, v146, v234
    v_mul_f32 v147, v147, v235
    v_mul_f32 v148, v148, v236
    v_mfma_f32_32x32x16_bf16 v[176:191], v[204:207], v[116:119], v[176:191]
    ds_read_b64_tr_b16 v[196:197], v217 offset:6144
    ds_read_b64_tr_b16 v[198:199], v217 offset:6656
    v_mul_f32 v149, v149, v237
    v_mul_f32 v150, v150, v238
    v_mul_f32 v151, v151, v239
    v_cvt_pk_bf16_f32 v152, v144, v145
    s_waitcnt lgkmcnt(4)
    v_mfma_f32_32x32x16_bf16 v[160:175], v[208:211], v[120:123], v[160:175]
    v_and_b32 v247, 63, v255
    v_lshrrev_b32 v248, 5, v247
    v_lshlrev_b32 v248, 3, v248
    v_bfe_u32 v249, v247, 2, 2
    v_add_u32 v248, v248, v249
    v_lshlrev_b32 v216, 7, v248
    v_bfe_u32 v248, v247, 1, 1
    v_bfe_u32 v249, v247, 4, 1
    s_lshl_b32 s66, s62, 2
    v_add_u32 v248, s66, v248
    v_lshl_add_u32 v248, v249, 1, v248
    v_bfe_u32 v249, v247, 3, 1
    v_lshlrev_b32 v249, 2, v249
    v_xor_b32 v248, v248, v249
    v_lshl_add_u32 v216, v248, 4, v216
    v_and_b32 v248, 1, v247
    v_lshl_add_u32 v216, v248, 3, v216
    ds_read_b64_tr_b16 v[200:201], v216 offset:16384
    ds_read_b64_tr_b16 v[202:203], v216 offset:16896
    v_cvt_pk_bf16_f32 v153, v146, v147
    v_cvt_pk_bf16_f32 v154, v148, v149
    v_mfma_f32_32x32x16_bf16 v[176:191], v[212:215], v[120:123], v[176:191]
    ds_read_b64_tr_b16 v[204:205], v216 offset:18432
    ds_read_b64_tr_b16 v[206:207], v216 offset:18944
    v_cvt_pk_bf16_f32 v155, v150, v151
    s_add_u32 s67, s3, 1024
    buffer_store_dwordx4 v[152:155], v254, s[28:31], s67 offen sc1
    s_waitcnt lgkmcnt(4)
    v_mfma_f32_32x32x16_bf16 v[160:175], v[192:195], v[124:127], v[160:175]
    ds_read_b64_tr_b16 v[208:209], v216 offset:20480
    ds_read_b64_tr_b16 v[210:211], v216 offset:20992
    v_mfma_f32_32x32x16_bf16 v[176:191], v[196:199], v[124:127], v[176:191]
    ds_read_b64_tr_b16 v[212:213], v216 offset:22528
    ds_read_b64_tr_b16 v[214:215], v216 offset:23040
    s_waitcnt vmcnt(10)
    s_barrier
    s_waitcnt lgkmcnt(4)
    v_mfma_f32_32x32x16_bf16 v[128:143], v[200:203], v[0:3], 0
    ds_read_b64_tr_b16 v[192:193], v216 offset:24576
    ds_read_b64_tr_b16 v[194:195], v216 offset:25088
    s_add_u32 s66, s50, 98304
    s_add_u32 m0, s73, 0
    s_nop 0
    buffer_load_dwordx4 v253, s[40:43], s66 offen lds
    s_lshl_b32 s3, s65, 3
    s_lshl_b32 s67, s62, 1
    s_add_u32 s3, s3, s67
    s_lshl_b32 s3, s3, 10
    v_mfma_f32_32x32x16_bf16 v[128:143], v[204:207], v[4:7], v[128:143]
    ds_read_b64_tr_b16 v[196:197], v216 offset:26624
    ds_read_b64_tr_b16 v[198:199], v216 offset:27136
    s_add_u32 s66, s50, 106496
    s_add_u32 m0, s73, 1024
    s_nop 0
    buffer_load_dwordx4 v253, s[40:43], s66 offen lds
    ds_read_b32 v240, v252 offset:512
    ds_read_b32 v242, v252 offset:576
    s_waitcnt lgkmcnt(6)
    v_mfma_f32_32x32x16_bf16 v[128:143], v[208:211], v[8:11], v[128:143]
    ds_read_b64_tr_b16 v[200:201], v216 offset:28672
    ds_read_b64_tr_b16 v[202:203], v216 offset:29184
    s_add_u32 s66, s50, 131072
    s_add_u32 m0, s73, 98304
    s_nop 0
    buffer_load_dwordx4 v253, s[40:43], s66 offen lds
    v_mfma_f32_32x32x16_bf16 v[128:143], v[212:215], v[12:15], v[128:143]
    ds_read_b64_tr_b16 v[204:205], v216 offset:30720
    ds_read_b64_tr_b16 v[206:207], v216 offset:31232
    s_add_u32 s66, s50, 139264
    s_add_u32 m0, s73, 99328
    s_nop 0
    buffer_load_dwordx4 v253, s[40:43], s66 offen lds
    s_waitcnt lgkmcnt(6)
    v_mfma_f32_32x32x16_bf16 v[128:143], v[192:195], v[16:19], v[128:143]
    ds_read_b64_tr_b16 v[208:209], v216 offset:32768
    ds_read_b64_tr_b16 v[210:211], v216 offset:33280
    s_waitcnt lgkmcnt(7)
    v_cvt_pk_bf16_f32 v224, v240, v240
    v_lshlrev_b32 v241, 16, v224
    v_sub_f32 v241, v240, v241
    v_cvt_pk_bf16_f32 v225, v241, 0
    s_nop 1
    v_mfma_f32_32x32x16_bf16 v[160:175], v[224:227], v[228:231], v[160:175]
    v_mfma_f32_32x32x16_bf16 v[128:143], v[196:199], v[20:23], v[128:143]
    ds_read_b64_tr_b16 v[212:213], v216 offset:34816
    ds_read_b64_tr_b16 v[214:215], v216 offset:35328
    s_waitcnt lgkmcnt(8)
    v_cvt_pk_bf16_f32 v224, v242, v242
    v_lshlrev_b32 v243, 16, v224
    v_sub_f32 v243, v242, v243
    v_cvt_pk_bf16_f32 v225, v243, 0
    s_nop 1
    v_mfma_f32_32x32x16_bf16 v[176:191], v[224:227], v[228:231], v[176:191]
    s_waitcnt lgkmcnt(4)
    v_mfma_f32_32x32x16_bf16 v[128:143], v[200:203], v[24:27], v[128:143]
    ds_read_b64_tr_b16 v[192:193], v216 offset:36864
    ds_read_b64_tr_b16 v[194:195], v216 offset:37376
    v_mfma_f32_32x32x16_bf16 v[128:143], v[204:207], v[28:31], v[128:143]
    ds_read_b64_tr_b16 v[196:197], v216 offset:38912
    ds_read_b64_tr_b16 v[198:199], v216 offset:39424
    s_waitcnt lgkmcnt(4)
    v_mfma_f32_32x32x16_bf16 v[128:143], v[208:211], v[32:35], v[128:143]
    ds_read_b64_tr_b16 v[200:201], v216 offset:40960
    ds_read_b64_tr_b16 v[202:203], v216 offset:41472
    v_mul_f32 v232, v160, v160
    v_mul_f32 v233, v161, v161
    v_mul_f32 v234, v162, v162
    v_mul_f32 v235, v163, v163
    v_mul_f32 v236, v164, v164
    v_mul_f32 v237, v165, v165
    v_mfma_f32_32x32x16_bf16 v[128:143], v[212:215], v[36:39], v[128:143]
    ds_read_b64_tr_b16 v[204:205], v216 offset:43008
    ds_read_b64_tr_b16 v[206:207], v216 offset:43520
    v_mul_f32 v238, v166, v166
    v_mul_f32 v239, v167, v167
    v_fma_f32 v232, v232, v221, v220
    v_fma_f32 v233, v233, v221, v220
    v_fma_f32 v234, v234, v221, v220
    v_fma_f32 v235, v235, v221, v220
    v_fma_f32 v236, v236, v221, v220
    s_waitcnt lgkmcnt(4)
    v_mfma_f32_32x32x16_bf16 v[128:143], v[192:195], v[40:43], v[128:143]
    ds_read_b64_tr_b16 v[208:209], v216 offset:45056
    ds_read_b64_tr_b16 v[210:211], v216 offset:45568
    v_fma_f32 v237, v237, v221, v220
    v_fma_f32 v238, v238, v221, v220
    v_fma_f32 v239, v239, v221, v220
    v_mul_f32 v232, v232, v160
    v_mul_f32 v233, v233, v161
    v_mul_f32 v234, v234, v162
    v_mul_f32 v235, v235, v163
    v_mfma_f32_32x32x16_bf16 v[128:143], v[196:199], v[44:47], v[128:143]
    ds_read_b64_tr_b16 v[212:213], v216 offset:47104
    ds_read_b64_tr_b16 v[214:215], v216 offset:47616
    v_mul_f32 v236, v236, v164
    v_mul_f32 v237, v237, v165
    v_mul_f32 v238, v238, v166
    v_mul_f32 v239, v239, v167
    v_exp_f32 v232, v232
    v_exp_f32 v233, v233
    v_exp_f32 v234, v234
    s_waitcnt lgkmcnt(4)
    v_mfma_f32_32x32x16_bf16 v[128:143], v[200:203], v[48:51], v[128:143]
    v_add_u32 v216, 0x10000, v216
    ds_read_b64_tr_b16 v[192:193], v216 offset:0
    ds_read_b64_tr_b16 v[194:195], v216 offset:512
    v_exp_f32 v235, v235
    v_exp_f32 v236, v236
    v_exp_f32 v237, v237
    v_exp_f32 v238, v238
    v_exp_f32 v239, v239
    v_mul_f32 v160, v160, v168
    v_mul_f32 v161, v161, v169
    v_mfma_f32_32x32x16_bf16 v[128:143], v[204:207], v[52:55], v[128:143]
    ds_read_b64_tr_b16 v[196:197], v216 offset:2048
    ds_read_b64_tr_b16 v[198:199], v216 offset:2560
    v_mul_f32 v162, v162, v170
    v_mul_f32 v163, v163, v171
    v_mul_f32 v164, v164, v172
    v_mul_f32 v165, v165, v173
    v_mul_f32 v166, v166, v174
    v_mul_f32 v167, v167, v175
    v_fma_f32 v232, v232, v222, v222
    s_waitcnt lgkmcnt(4)
    v_mfma_f32_32x32x16_bf16 v[128:143], v[208:211], v[56:59], v[128:143]
    ds_read_b64_tr_b16 v[200:201], v216 offset:4096
    ds_read_b64_tr_b16 v[202:203], v216 offset:4608
    v_fma_f32 v233, v233, v222, v222
    v_fma_f32 v234, v234, v222, v222
    v_fma_f32 v235, v235, v222, v222
    v_fma_f32 v236, v236, v222, v222
    v_fma_f32 v237, v237, v222, v222
    v_fma_f32 v238, v238, v222, v222
    v_fma_f32 v239, v239, v222, v222
    v_mfma_f32_32x32x16_bf16 v[128:143], v[212:215], v[60:63], v[128:143]
    ds_read_b64_tr_b16 v[204:205], v216 offset:6144
    ds_read_b64_tr_b16 v[206:207], v216 offset:6656
    v_rcp_f32 v232, v232
    v_rcp_f32 v233, v233
    v_rcp_f32 v234, v234
    v_rcp_f32 v235, v235
    v_rcp_f32 v236, v236
    v_rcp_f32 v237, v237
    v_rcp_f32 v238, v238
    s_waitcnt vmcnt(9)
    s_barrier
    s_waitcnt lgkmcnt(4)
    v_mfma_f32_32x32x16_bf16 v[128:143], v[192:195], v[64:67], v[128:143]
    ds_read_b64_tr_b16 v[208:209], v216 offset:8192
    ds_read_b64_tr_b16 v[210:211], v216 offset:8704
    s_add_u32 s66, s50, 163840
    s_add_u32 m0, s73, 16384
    s_nop 0
    buffer_load_dwordx4 v253, s[40:43], s66 offen lds
    v_rcp_f32 v239, v239
    v_mul_f32 v160, v160, v232
    v_mul_f32 v161, v161, v233
    v_mul_f32 v162, v162, v234
    v_mul_f32 v163, v163, v235
    v_mul_f32 v164, v164, v236
    v_mul_f32 v165, v165, v237
    v_mfma_f32_32x32x16_bf16 v[128:143], v[196:199], v[68:71], v[128:143]
    ds_read_b64_tr_b16 v[212:213], v216 offset:10240
    ds_read_b64_tr_b16 v[214:215], v216 offset:10752
    s_add_u32 s66, s50, 172032
    s_add_u32 m0, s73, 17408
    s_nop 0
    buffer_load_dwordx4 v253, s[40:43], s66 offen lds
    v_mul_f32 v166, v166, v238
    v_mul_f32 v167, v167, v239
    v_cvt_pk_bf16_f32 v168, v160, v161
    v_cvt_pk_bf16_f32 v169, v162, v163
    v_cvt_pk_bf16_f32 v170, v164, v165
    v_cvt_pk_bf16_f32 v171, v166, v167
    s_add_u32 s67, s3, 4096
    buffer_store_dwordx4 v[168:171], v254, s[28:31], s67 offen sc1
    s_waitcnt lgkmcnt(4)
    v_mfma_f32_32x32x16_bf16 v[128:143], v[200:203], v[72:75], v[128:143]
    ds_read_b64_tr_b16 v[192:193], v216 offset:12288
    ds_read_b64_tr_b16 v[194:195], v216 offset:12800
    s_add_u32 s66, s50, 196608
    s_add_u32 m0, s73, 32768
    s_nop 0
    buffer_load_dwordx4 v253, s[40:43], s66 offen lds
    v_mul_f32 v232, v176, v176
    v_mul_f32 v233, v177, v177
    v_mul_f32 v234, v178, v178
    v_mul_f32 v235, v179, v179
    v_mul_f32 v236, v180, v180
    v_mul_f32 v237, v181, v181
    v_mul_f32 v238, v182, v182
    v_mfma_f32_32x32x16_bf16 v[128:143], v[204:207], v[76:79], v[128:143]
    ds_read_b64_tr_b16 v[196:197], v216 offset:14336
    ds_read_b64_tr_b16 v[198:199], v216 offset:14848
    s_add_u32 s66, s50, 204800
    s_add_u32 m0, s73, 33792
    s_nop 0
    buffer_load_dwordx4 v253, s[40:43], s66 offen lds
    v_mul_f32 v239, v183, v183
    v_fma_f32 v232, v232, v221, v220
    v_fma_f32 v233, v233, v221, v220
    v_fma_f32 v234, v234, v221, v220
    v_fma_f32 v235, v235, v221, v220
    v_fma_f32 v236, v236, v221, v220
    v_fma_f32 v237, v237, v221, v220
    s_waitcnt lgkmcnt(4)
    v_mfma_f32_32x32x16_bf16 v[128:143], v[208:211], v[80:83], v[128:143]
    v_add_u32 v216, 0xffff0000, v216
    ds_read_b64_tr_b16 v[200:201], v216 offset:49152
    ds_read_b64_tr_b16 v[202:203], v216 offset:49664
    v_fma_f32 v238, v238, v221, v220
    v_fma_f32 v239, v239, v221, v220
    v_mul_f32 v232, v232, v176
    v_mul_f32 v233, v233, v177
    v_mul_f32 v234, v234, v178
    v_mul_f32 v235, v235, v179
    v_mul_f32 v236, v236, v180
    v_mfma_f32_32x32x16_bf16 v[128:143], v[212:215], v[84:87], v[128:143]
    ds_read_b64_tr_b16 v[204:205], v216 offset:51200
    ds_read_b64_tr_b16 v[206:207], v216 offset:51712
    v_mul_f32 v237, v237, v181
    v_mul_f32 v238, v238, v182
    v_mul_f32 v239, v239, v183
    v_exp_f32 v232, v232
    v_exp_f32 v233, v233
    v_exp_f32 v234, v234
    v_exp_f32 v235, v235
    s_waitcnt lgkmcnt(4)
    v_mfma_f32_32x32x16_bf16 v[128:143], v[192:195], v[88:91], v[128:143]
    ds_read_b64_tr_b16 v[208:209], v216 offset:53248
    ds_read_b64_tr_b16 v[210:211], v216 offset:53760
    v_exp_f32 v236, v236
    v_exp_f32 v237, v237
    v_exp_f32 v238, v238
    v_exp_f32 v239, v239
    v_mul_f32 v176, v176, v184
    v_mul_f32 v177, v177, v185
    v_mul_f32 v178, v178, v186
    v_mfma_f32_32x32x16_bf16 v[128:143], v[196:199], v[92:95], v[128:143]
    ds_read_b64_tr_b16 v[212:213], v216 offset:55296
    ds_read_b64_tr_b16 v[214:215], v216 offset:55808
    v_mul_f32 v179, v179, v187
    v_mul_f32 v180, v180, v188
    v_mul_f32 v181, v181, v189
    v_mul_f32 v182, v182, v190
    v_mul_f32 v183, v183, v191
    v_fma_f32 v232, v232, v222, v222
    v_fma_f32 v233, v233, v222, v222
    s_waitcnt lgkmcnt(4)
    v_mfma_f32_32x32x16_bf16 v[128:143], v[200:203], v[96:99], v[128:143]
    ds_read_b64_tr_b16 v[192:193], v216 offset:57344
    ds_read_b64_tr_b16 v[194:195], v216 offset:57856
    v_fma_f32 v234, v234, v222, v222
    v_fma_f32 v235, v235, v222, v222
    v_fma_f32 v236, v236, v222, v222
    v_fma_f32 v237, v237, v222, v222
    v_fma_f32 v238, v238, v222, v222
    v_fma_f32 v239, v239, v222, v222
    v_rcp_f32 v232, v232
    v_mfma_f32_32x32x16_bf16 v[128:143], v[204:207], v[100:103], v[128:143]
    ds_read_b64_tr_b16 v[196:197], v216 offset:59392
    ds_read_b64_tr_b16 v[198:199], v216 offset:59904
    v_rcp_f32 v233, v233
    v_rcp_f32 v234, v234
    v_rcp_f32 v235, v235
    v_rcp_f32 v236, v236
    v_rcp_f32 v237, v237
    v_rcp_f32 v238, v238
    v_rcp_f32 v239, v239
    s_waitcnt lgkmcnt(4)
    v_mfma_f32_32x32x16_bf16 v[128:143], v[208:211], v[104:107], v[128:143]
    ds_read_b64_tr_b16 v[200:201], v216 offset:61440
    ds_read_b64_tr_b16 v[202:203], v216 offset:61952
    v_mul_f32 v176, v176, v232
    v_mul_f32 v177, v177, v233
    v_mul_f32 v178, v178, v234
    v_mul_f32 v179, v179, v235
    v_mul_f32 v180, v180, v236
    v_mul_f32 v181, v181, v237
    v_mfma_f32_32x32x16_bf16 v[128:143], v[212:215], v[108:111], v[128:143]
    ds_read_b64_tr_b16 v[204:205], v216 offset:63488
    ds_read_b64_tr_b16 v[206:207], v216 offset:64000
    v_mul_f32 v182, v182, v238
    v_mul_f32 v183, v183, v239
    v_cvt_pk_bf16_f32 v184, v176, v177
    v_cvt_pk_bf16_f32 v185, v178, v179
    v_cvt_pk_bf16_f32 v186, v180, v181
    v_cvt_pk_bf16_f32 v187, v182, v183
    s_add_u32 s67, s3, 5120
    buffer_store_dwordx4 v[184:187], v254, s[28:31], s67 offen sc1
    s_waitcnt lgkmcnt(4)
    v_mfma_f32_32x32x16_bf16 v[128:143], v[192:195], v[112:115], v[128:143]
    v_mfma_f32_32x32x16_bf16 v[128:143], v[196:199], v[116:119], v[128:143]
    s_waitcnt lgkmcnt(0)
    v_mfma_f32_32x32x16_bf16 v[128:143], v[200:203], v[120:123], v[128:143]
    v_mfma_f32_32x32x16_bf16 v[128:143], v[204:207], v[124:127], v[128:143]
    v_and_b32 v248, 31, v255
    v_lshlrev_b32 v248, 2, v248
    s_lshl_b32 s67, s62, 7
    s_add_u32 s67, s67, 147456
    v_add_u32 v252, s67, v248
    v_mov_b32 v248, 0x24600
    s_mov_b32 s100, 0
    s_mov_b32 s101, -1
    v_cndmask_b32 v252, v252, v248, s[100:101]
    ds_read_b32 v232, v252 offset:1024
    s_waitcnt lgkmcnt(0)
    v_cvt_pk_bf16_f32 v224, v232, v232
    v_lshlrev_b32 v233, 16, v224
    v_sub_f32 v233, v232, v233
    v_cvt_pk_bf16_f32 v225, v233, 0
    s_nop 1
    v_mfma_f32_32x32x16_bf16 v[128:143], v[224:227], v[228:231], v[128:143]
    s_nop 11
    v_mul_f32 v128, v223, v128
    v_mul_f32 v129, v223, v129
    v_mul_f32 v130, v223, v130
    v_mul_f32 v131, v223, v131
    v_mul_f32 v132, v223, v132
    v_mul_f32 v133, v223, v133
    v_mul_f32 v134, v223, v134
    v_mul_f32 v135, v223, v135
    v_mul_f32 v136, v223, v136
    v_mul_f32 v137, v223, v137
    v_mul_f32 v138, v223, v138
    v_mul_f32 v139, v223, v139
    v_mul_f32 v140, v223, v140
    v_mul_f32 v141, v223, v141
    v_mul_f32 v142, v223, v142
    v_mul_f32 v143, v223, v143
    v_mul_f32 v232, s70, v128
    v_mul_f32 v233, s70, v129
    v_mul_f32 v234, s70, v130
    v_mul_f32 v235, s70, v131
    v_mul_f32 v236, s70, v132
    v_mul_f32 v237, s70, v133
    v_mul_f32 v238, s70, v134
    v_mul_f32 v239, s70, v135
    v_min_f32 v232, 0, v232
    v_min_f32 v233, 0, v233
    v_min_f32 v234, 0, v234
    v_min_f32 v235, 0, v235
    v_min_f32 v236, 0, v236
    v_min_f32 v237, 0, v237
    v_min_f32 v238, 0, v238
    v_min_f32 v239, 0, v239
    v_exp_f32 v232, v232
    v_exp_f32 v233, v233
    v_exp_f32 v234, v234
    v_exp_f32 v235, v235
    v_exp_f32 v236, v236
    v_exp_f32 v237, v237
    v_exp_f32 v238, v238
    v_exp_f32 v239, v239
    v_max_f32 v128, 0, v128
    v_max_f32 v129, 0, v129
    v_max_f32 v130, 0, v130
    v_max_f32 v131, 0, v131
    v_max_f32 v132, 0, v132
    v_max_f32 v133, 0, v133
    v_max_f32 v134, 0, v134
    v_max_f32 v135, 0, v135
    v_add_f32 v232, s71, v232
    v_add_f32 v233, s71, v233
    v_add_f32 v234, s71, v234
    v_add_f32 v235, s71, v235
    v_add_f32 v236, s71, v236
    v_add_f32 v237, s71, v237
    v_add_f32 v238, s71, v238
    v_add_f32 v239, s71, v239
    v_add_f32 v128, v128, v232
    v_add_f32 v129, v129, v233
    v_add_f32 v130, v130, v234
    v_add_f32 v131, v131, v235
    v_add_f32 v132, v132, v236
    v_add_f32 v133, v133, v237
    v_add_f32 v134, v134, v238
    v_add_f32 v135, v135, v239
    v_mul_f32 v232, s70, v136
    v_mul_f32 v233, s70, v137
    v_mul_f32 v234, s70, v138
    v_mul_f32 v235, s70, v139
    v_mul_f32 v236, s70, v140
    v_mul_f32 v237, s70, v141
    v_mul_f32 v238, s70, v142
    v_mul_f32 v239, s70, v143
    v_min_f32 v232, 0, v232
    v_min_f32 v233, 0, v233
    v_min_f32 v234, 0, v234
    v_min_f32 v235, 0, v235
    v_min_f32 v236, 0, v236
    v_min_f32 v237, 0, v237
    v_min_f32 v238, 0, v238
    v_min_f32 v239, 0, v239
    v_exp_f32 v232, v232
    v_exp_f32 v233, v233
    v_exp_f32 v234, v234
    v_exp_f32 v235, v235
    v_exp_f32 v236, v236
    v_exp_f32 v237, v237
    v_exp_f32 v238, v238
    v_exp_f32 v239, v239
    v_max_f32 v136, 0, v136
    v_max_f32 v137, 0, v137
    v_max_f32 v138, 0, v138
    v_max_f32 v139, 0, v139
    v_max_f32 v140, 0, v140
    v_max_f32 v141, 0, v141
    v_max_f32 v142, 0, v142
    v_max_f32 v143, 0, v143
    v_add_f32 v232, s71, v232
    v_add_f32 v233, s71, v233
    v_add_f32 v234, s71, v234
    v_add_f32 v235, s71, v235
    v_add_f32 v236, s71, v236
    v_add_f32 v237, s71, v237
    v_add_f32 v238, s71, v238
    v_add_f32 v239, s71, v239
    v_add_f32 v136, v136, v232
    v_add_f32 v137, v137, v233
    v_add_f32 v138, v138, v234
    v_add_f32 v139, v139, v235
    v_add_f32 v140, v140, v236
    v_add_f32 v141, v141, v237
    v_add_f32 v142, v142, v238
    v_add_f32 v143, v143, v239
    v_cvt_pk_bf16_f32 v240, v128, v129
    v_cvt_pk_bf16_f32 v241, v130, v131
    v_cvt_pk_bf16_f32 v242, v132, v133
    v_cvt_pk_bf16_f32 v243, v134, v135
    v_cvt_pk_bf16_f32 v244, v136, v137
    v_cvt_pk_bf16_f32 v245, v138, v139
    v_cvt_pk_bf16_f32 v246, v140, v141
    v_cvt_pk_bf16_f32 v247, v142, v143
    s_waitcnt vmcnt(0)
    s_barrier
    s_cmp_lg_u32 s60, 0
    s_cbranch_scc1 L_cnt24
    s_add_u32 s66, s63, 40
    s_lshl_b32 s66, s66, 5
    s_add_u32 s66, s66, s64
    s_lshl_b32 s66, s66, 2
    v_mov_b32 v250, s66
    v_mov_b32 v251, 1
    s_mov_b64 s[76:77], exec
    s_mov_b64 exec, 1
    buffer_store_dword v251, v250, s[36:39], 0 offen sc1
    s_mov_b64 exec, s[76:77]
    s_nop 1
L_cnt24:
    s_add_u32 s66, s65, 32
    s_lshl_b32 s66, s66, 7
    v_and_b32 v250, 15, v255
    v_lshlrev_b32 v250, 2, v250
    v_add_u32 v250, s66, v250
    s_mov_b32 s78, 0x40000
L_spin25:
    buffer_load_dword v251, v250, s[36:39], 0 offen sc1
    s_waitcnt vmcnt(0)
    v_cmp_ne_u32 vcc, 0, v251
    s_nop 3
    s_and_b32 s66, vcc_lo, 0xffff
    s_cmp_eq_u32 s66, 0xffff
    s_cbranch_scc1 L_spun25
    s_sleep 8
    s_sub_u32 s78, s78, 1
    s_cbranch_scc0 L_spin25
L_spun25:
    v_lshlrev_b32 v232, 4, v255
    v_mov_b32 v233, 0x7ff00000
    v_cmp_gt_u32 vcc, 272, v255
    s_nop 1
    v_cndmask_b32 v232, v233, v232, vcc
    s_mov_b32 s68, 0
    buffer_load_dwordx4 v[0:3], v232, s[32:35], s68 offen sc1
    s_mov_b32 s68, 4352
    buffer_load_dwordx4 v[4:7], v232, s[32:35], s68 offen sc1
    s_mov_b32 s68, 8704
    buffer_load_dwordx4 v[8:11], v232, s[32:35], s68 offen sc1
    s_mov_b32 s68, 13056
    buffer_load_dwordx4 v[12:15], v232, s[32:35], s68 offen sc1
    s_mov_b32 s68, 17408
    buffer_load_dwordx4 v[16:19], v232, s[32:35], s68 offen sc1
    s_mov_b32 s68, 21760
    buffer_load_dwordx4 v[20:23], v232, s[32:35], s68 offen sc1
    s_mov_b32 s68, 26112
    buffer_load_dwordx4 v[24:27], v232, s[32:35], s68 offen sc1
    s_mov_b32 s68, 30464
    buffer_load_dwordx4 v[28:31], v232, s[32:35], s68 offen sc1
    s_mov_b32 s68, 34816
    buffer_load_dwordx4 v[32:35], v232, s[32:35], s68 offen sc1
    s_mov_b32 s68, 39168
    buffer_load_dwordx4 v[36:39], v232, s[32:35], s68 offen sc1
    s_mov_b32 s68, 43520
    buffer_load_dwordx4 v[40:43], v232, s[32:35], s68 offen sc1
    s_mov_b32 s68, 47872
    buffer_load_dwordx4 v[44:47], v232, s[32:35], s68 offen sc1
    s_mov_b32 s68, 52224
    buffer_load_dwordx4 v[48:51], v232, s[32:35], s68 offen sc1
    s_mov_b32 s68, 56576
    buffer_load_dwordx4 v[52:55], v232, s[32:35], s68 offen sc1
    s_mov_b32 s68, 60928
    buffer_load_dwordx4 v[56:59], v232, s[32:35], s68 offen sc1
    s_mov_b32 s68, 65280
    buffer_load_dwordx4 v[60:63], v232, s[32:35], s68 offen sc1
    s_add_u32 s66, s50, 229376
    s_add_u32 m0, s73, 49152
    s_nop 0
    buffer_load_dwordx4 v253, s[40:43], s66 offen lds
    s_add_u32 s66, s50, 237568
    s_add_u32 m0, s73, 50176
    s_nop 0
    buffer_load_dwordx4 v253, s[40:43], s66 offen lds
    s_add_u32 s66, s50, 262144
    s_add_u32 m0, s73, 65536
    s_nop 0
    buffer_load_dwordx4 v253, s[40:43], s66 offen lds
    s_add_u32 s66, s50, 270336
    s_add_u32 m0, s73, 66560
    s_nop 0
    buffer_load_dwordx4 v253, s[40:43], s66 offen lds
    s_waitcnt vmcnt(18)
    v_add_f32 v0, v0, v4
    v_add_f32 v1, v1, v5
    v_add_f32 v2, v2, v6
    v_add_f32 v3, v3, v7
    s_waitcnt vmcnt(16)
    v_add_f32 v8, v8, v12
    v_add_f32 v9, v9, v13
    v_add_f32 v10, v10, v14
    v_add_f32 v11, v11, v15
    s_waitcnt vmcnt(14)
    v_add_f32 v16, v16, v20
    v_add_f32 v17, v17, v21
    v_add_f32 v18, v18, v22
    v_add_f32 v19, v19, v23
    s_waitcnt vmcnt(12)
    v_add_f32 v24, v24, v28
    v_add_f32 v25, v25, v29
    v_add_f32 v26, v26, v30
    v_add_f32 v27, v27, v31
    s_waitcnt vmcnt(10)
    v_add_f32 v32, v32, v36
    v_add_f32 v33, v33, v37
    v_add_f32 v34, v34, v38
    v_add_f32 v35, v35, v39
    s_waitcnt vmcnt(8)
    v_add_f32 v40, v40, v44
    v_add_f32 v41, v41, v45
    v_add_f32 v42, v42, v46
    v_add_f32 v43, v43, v47
    s_waitcnt vmcnt(6)
    v_add_f32 v48, v48, v52
    v_add_f32 v49, v49, v53
    v_add_f32 v50, v50, v54
    v_add_f32 v51, v51, v55
    s_waitcnt vmcnt(4)
    v_add_f32 v56, v56, v60
    v_add_f32 v57, v57, v61
    v_add_f32 v58, v58, v62
    v_add_f32 v59, v59, v63
    v_add_f32 v0, v0, v8
    v_add_f32 v1, v1, v9
    v_add_f32 v2, v2, v10
    v_add_f32 v3, v3, v11
    v_add_f32 v16, v16, v24
    v_add_f32 v17, v17, v25
    v_add_f32 v18, v18, v26
    v_add_f32 v19, v19, v27
    v_add_f32 v32, v32, v40
    v_add_f32 v33, v33, v41
    v_add_f32 v34, v34, v42
    v_add_f32 v35, v35, v43
    v_add_f32 v48, v48, v56
    v_add_f32 v49, v49, v57
    v_add_f32 v50, v50, v58
    v_add_f32 v51, v51, v59
    v_add_f32 v0, v0, v16
    v_add_f32 v1, v1, v17
    v_add_f32 v2, v2, v18
    v_add_f32 v3, v3, v19
    v_add_f32 v32, v32, v48
    v_add_f32 v33, v33, v49
    v_add_f32 v34, v34, v50
    v_add_f32 v35, v35, v51
    v_add_f32 v0, v0, v32
    v_add_f32 v1, v1, v33
    v_add_f32 v2, v2, v34
    v_add_f32 v3, v3, v35
    v_lshlrev_b32 v232, 4, v255
    v_add_u32 v232, 0x25000, v232
    v_cmp_gt_u32 vcc, 272, v255
    s_nop 1
    s_and_saveexec_b64 s[76:77], vcc
    ds_write_b128 v232, v[0:3]
    s_mov_b64 exec, s[76:77]
    s_waitcnt lgkmcnt(0)
    s_barrier
    v_and_b32 v232, 63, v255
    v_and_b32 v233, 31, v232
    v_lshrrev_b32 v232, 5, v232
    v_lshlrev_b32 v235, 6, v233
    s_lshl_b32 s66, s62, 11
    v_add_u32 v235, s66, v235
    s_lshl_b32 s66, s62, 7
    s_add_u32 s66, s66, 4096
    v_mov_b32 v236, s66
    v_mov_b32 v237, 1024
    v_mov_b32 v238, 64
    v_cmp_gt_u32 vcc, 16, v233
    s_nop 1
    v_cndmask_b32 v235, v236, v235, vcc
    v_cndmask_b32 v237, v238, v237, vcc
    v_lshl_add_u32 v235, v232, 4, v235
    v_add_u32 v235, 0x25000, v235
    v_add_u32 v236, v235, v237
    ds_read_b128 v[64:67], v235
    ds_read_b128 v[68:71], v235 offset:32
    ds_read_b128 v[72:75], v236
    ds_read_b128 v[76:79], v236 offset:32
    s_waitcnt lgkmcnt(3)
    v_cvt_pk_bf16_f32 v80, v64, v65
    v_cvt_pk_bf16_f32 v81, v66, v67
    s_waitcnt lgkmcnt(2)
    v_cvt_pk_bf16_f32 v82, v68, v69
    v_cvt_pk_bf16_f32 v83, v70, v71
    s_waitcnt lgkmcnt(1)
    v_cvt_pk_bf16_f32 v84, v72, v73
    v_cvt_pk_bf16_f32 v85, v74, v75
    s_waitcnt lgkmcnt(0)
    v_cvt_pk_bf16_f32 v86, v76, v77
    v_cvt_pk_bf16_f32 v87, v78, v79
    v_mfma_f32_32x32x16_bf16 v[128:143], v[80:83], v[240:243], 0
    s_nop 0
    v_mfma_f32_32x32x16_bf16 v[160:175], v[84:87], v[244:247], 0
    s_lshl_b32 s3, s65, 2
    s_lshl_b32 s67, s62, 1
    s_add_u32 s3, s3, s67
    s_add_u32 s3, s3, 112
    s_lshl_b32 s3, s3, 10
    s_nop 4
    v_add_f32 v136, s71, v136
    v_rcp_f32 v136, v136
    s_nop 0
    v_mul_f32 v128, v128, v136
    v_mul_f32 v129, v129, v136
    v_mul_f32 v130, v130, v136
    v_mul_f32 v131, v131, v136
    v_mul_f32 v132, v132, v136
    v_mul_f32 v133, v133, v136
    v_mul_f32 v134, v134, v136
    v_mul_f32 v135, v135, v136
    v_cvt_pk_bf16_f32 v140, v128, v129
    v_cvt_pk_bf16_f32 v141, v130, v131
    v_cvt_pk_bf16_f32 v142, v132, v133
    v_cvt_pk_bf16_f32 v143, v134, v135
    buffer_store_dwordx4 v[140:143], v254, s[28:31], s3 offen offset:0 sc1
    v_add_f32 v168, s71, v168
    v_rcp_f32 v168, v168
    s_nop 0
    v_mul_f32 v160, v160, v168
    v_mul_f32 v161, v161, v168
    v_mul_f32 v162, v162, v168
    v_mul_f32 v163, v163, v168
    v_mul_f32 v164, v164, v168
    v_mul_f32 v165, v165, v168
    v_mul_f32 v166, v166, v168
    v_mul_f32 v167, v167, v168
    v_cvt_pk_bf16_f32 v172, v160, v161
    v_cvt_pk_bf16_f32 v173, v162, v163
    v_cvt_pk_bf16_f32 v174, v164, v165
    v_cvt_pk_bf16_f32 v175, v166, v167
    buffer_store_dwordx4 v[172:175], v254, s[28:31], s3 offen offset:1024 sc1
    v_and_b32 v0, 63, v255
    v_lshrrev_b32 v1, 5, v0
    v_lshlrev_b32 v1, 2, v1
    v_bfe_u32 v2, v0, 2, 2
    v_add_u32 v1, v1, v2
    v_lshlrev_b32 v236, 7, v1
    v_bfe_u32 v1, v0, 4, 1
    v_lshlrev_b32 v1, 1, v1
    v_bfe_u32 v2, v0, 1, 1
    v_add_u32 v1, v1, v2
    v_bfe_u32 v2, v0, 3, 1
    v_lshlrev_b32 v2, 2, v2
    v_xor_b32 v1, v1, v2
    v_lshl_add_u32 v236, v1, 4, v236
    v_and_b32 v1, 1, v0
    v_lshl_add_u32 v236, v1, 3, v236
    s_lshl_b32 s66, s48, 12
    v_add_u32 v236, s66, v236
    v_xor_b32 v237, 64, v236
    s_mov_b32 s16, s4
    s_mov_b32 s17, s5
    s_mov_b32 s18, 2097152
    s_mov_b32 s19, 0x20000
    s_mov_b32 s20, s10
    s_mov_b32 s21, s11
    s_mov_b32 s22, 2097152
    s_mov_b32 s23, 0x20000
    v_lshrrev_b32 v1, 3, v255
    v_lshlrev_b32 v238, 10, v1
    v_and_b32 v1, 7, v255
    v_lshl_add_u32 v238, v1, 4, v238
    s_lshl_b32 s66, s74, 16
    s_lshl_b32 s67, s75, 7
    s_add_u32 s66, s66, s67
    v_add_u32 v238, s66, v238
    buffer_load_dwordx4 v[232:235], v238, s[16:19], 0 offen
    s_mov_b32 s24, s28
    s_mov_b32 s25, s29
    s_mov_b32 s26, s30
    s_mov_b32 s27, s31
    s_lshl_b32 s66, s74, 1
    s_add_u32 s66, s66, s49
    s_mul_i32 s66, s66, 147456
    s_add_u32 s28, s58, s66
    s_addc_u32 s29, s59, 0
    s_mov_b32 s30, 147456
    s_mov_b32 s31, 0x20000
    s_mul_i32 s14, s48, 28672
    s_lshl_b32 s15, s48, 13
    s_add_u32 s15, s15, 86016
    s_lshr_b32 s68, s74, 1
    s_add_u32 s66, s68, 40
    s_lshl_b32 s66, s66, 7
    v_and_b32 v239, 15, v255
    v_lshlrev_b32 v239, 2, v239
    v_add_u32 v239, s66, v239
    s_mov_b32 s78, 0x40000
L_spin26:
    buffer_load_dword v252, v239, s[36:39], 0 offen sc1
    s_waitcnt vmcnt(0)
    v_cmp_ne_u32 vcc, 0, v252
    s_nop 3
    s_and_b32 s66, vcc_lo, 0xffff
    s_cmp_eq_u32 s66, 0xffff
    s_cbranch_scc1 L_spun26
    s_sleep 8
    s_sub_u32 s78, s78, 1
    s_cbranch_scc0 L_spin26
L_spun26:
    s_add_u32 s67, s14, 0
    buffer_load_dwordx4 v[0:3], v254, s[28:31], s67 offen offset:0 sc1
    buffer_load_dwordx4 v[4:7], v254, s[28:31], s67 offen offset:1024 sc1
    buffer_load_dwordx4 v[8:11], v254, s[28:31], s67 offen offset:2048 sc1
    buffer_load_dwordx4 v[12:15], v254, s[28:31], s67 offen offset:3072 sc1
    s_add_u32 s67, s14, 4096
    buffer_load_dwordx4 v[16:19], v254, s[28:31], s67 offen offset:0 sc1
    buffer_load_dwordx4 v[20:23], v254, s[28:31], s67 offen offset:1024 sc1
    buffer_load_dwordx4 v[24:27], v254, s[28:31], s67 offen offset:2048 sc1
    buffer_load_dwordx4 v[28:31], v254, s[28:31], s67 offen offset:3072 sc1
    s_barrier
    v_add_u32 v236, 0x10000, v236
    v_add_u32 v237, 0x10000, v237
    ds_read_b64_tr_b16 v[208:209], v236 offset:49152
    ds_read_b64_tr_b16 v[210:211], v236 offset:50176
    ds_read_b64_tr_b16 v[212:213], v237 offset:49152
    ds_read_b64_tr_b16 v[214:215], v237 offset:50176
    ds_read_b64_tr_b16 v[216:217], v236 offset:51200
    ds_read_b64_tr_b16 v[218:219], v236 offset:52224
    ds_read_b64_tr_b16 v[220:221], v237 offset:51200
    ds_read_b64_tr_b16 v[222:223], v237 offset:52224
    s_waitcnt vmcnt(9)
    s_barrier
    s_cmp_lg_u32 s60, 0
    s_cbranch_scc1 L_cnt27
    s_add_u32 s66, s63, 56
    s_lshl_b32 s66, s66, 5
    s_add_u32 s66, s66, s65
    s_lshl_b32 s66, s66, 2
    v_mov_b32 v239, s66
    v_mov_b32 v252, 1
    s_mov_b64 s[76:77], exec
    s_mov_b64 exec, 1
    buffer_store_dword v252, v239, s[36:39], 0 offen sc1
    s_mov_b64 exec, s[76:77]
    s_nop 1
L_cnt27:
    s_waitcnt lgkmcnt(4)
    s_waitcnt vmcnt(7)
    v_mfma_f32_32x32x16_bf16 v[144:159], v[208:211], v[0:3], 0
    ds_read_b64_tr_b16 v[224:225], v236 offset:16384
    ds_read_b64_tr_b16 v[226:227], v236 offset:17408
    v_mfma_f32_32x32x16_bf16 v[160:175], v[212:215], v[0:3], 0
    ds_read_b64_tr_b16 v[228:229], v237 offset:16384
    ds_read_b64_tr_b16 v[230:231], v237 offset:17408
    s_add_u32 s67, s14, 8192
    buffer_load_dwordx4 v[32:35], v254, s[28:31], s67 offen offset:0 sc1
    s_waitcnt lgkmcnt(4)
    s_waitcnt vmcnt(7)
    v_mfma_f32_32x32x16_bf16 v[144:159], v[216:219], v[4:7], v[144:159]
    ds_read_b64_tr_b16 v[208:209], v236 offset:18432
    ds_read_b64_tr_b16 v[210:211], v236 offset:19456
    v_mfma_f32_32x32x16_bf16 v[160:175], v[220:223], v[4:7], v[160:175]
    ds_read_b64_tr_b16 v[212:213], v237 offset:18432
    ds_read_b64_tr_b16 v[214:215], v237 offset:19456
    s_add_u32 s67, s14, 8192
    buffer_load_dwordx4 v[36:39], v254, s[28:31], s67 offen offset:1024 sc1
    s_waitcnt lgkmcnt(4)
    s_waitcnt vmcnt(7)
    v_mfma_f32_32x32x16_bf16 v[144:159], v[224:227], v[8:11], v[144:159]
    v_add_u32 v236, 0x10000, v236
    v_add_u32 v237, 0x10000, v237
    ds_read_b64_tr_b16 v[216:217], v236 offset:0
    ds_read_b64_tr_b16 v[218:219], v236 offset:1024
    v_mfma_f32_32x32x16_bf16 v[160:175], v[228:231], v[8:11], v[160:175]
    ds_read_b64_tr_b16 v[220:221], v237 offset:0
    ds_read_b64_tr_b16 v[222:223], v237 offset:1024
    s_add_u32 s67, s14, 8192
    buffer_load_dwordx4 v[40:43], v254, s[28:31], s67 offen offset:2048 sc1
    s_waitcnt lgkmcnt(4)
    s_waitcnt vmcnt(7)
    v_mfma_f32_32x32x16_bf16 v[144:159], v[208:211], v[12:15], v[144:159]
    ds_read_b64_tr_b16 v[224:225], v236 offset:2048
    ds_read_b64_tr_b16 v[226:227], v236 offset:3072
    v_mfma_f32_32x32x16_bf16 v[160:175], v[212:215], v[12:15], v[160:175]
    ds_read_b64_tr_b16 v[228:229], v237 offset:2048
    ds_read_b64_tr_b16 v[230:231], v237 offset:3072
    s_add_u32 s67, s14, 8192
    buffer_load_dwordx4 v[44:47], v254, s[28:31], s67 offen offset:3072 sc1
    s_barrier
    s_waitcnt lgkmcnt(4)
    s_waitcnt vmcnt(7)
    v_mfma_f32_32x32x16_bf16 v[144:159], v[216:219], v[16:19], v[144:159]
    v_add_u32 v236, 0xfffe0000, v236
    v_add_u32 v237, 0xfffe0000, v237
    ds_read_b64_tr_b16 v[208:209], v236 offset:0
    ds_read_b64_tr_b16 v[210:211], v236 offset:1024
    s_add_u32 s66, s50, 294912
    s_add_u32 m0, s73, 81920
    s_nop 0
    buffer_load_dwordx4 v253, s[40:43], s66 offen lds
    v_mfma_f32_32x32x16_bf16 v[160:175], v[220:223], v[16:19], v[160:175]
    ds_read_b64_tr_b16 v[212:213], v237 offset:0
    ds_read_b64_tr_b16 v[214:215], v237 offset:1024
    s_add_u32 s66, s50, 303104
    s_add_u32 m0, s73, 82944
    s_nop 0
    buffer_load_dwordx4 v253, s[40:43], s66 offen lds
    s_add_u32 s67, s14, 12288
    buffer_load_dwordx4 v[48:51], v254, s[28:31], s67 offen offset:0 sc1
    s_waitcnt lgkmcnt(4)
    s_waitcnt vmcnt(9)
    v_mfma_f32_32x32x16_bf16 v[144:159], v[224:227], v[20:23], v[144:159]
    ds_read_b64_tr_b16 v[216:217], v236 offset:2048
    ds_read_b64_tr_b16 v[218:219], v236 offset:3072
    s_add_u32 s66, s50, 327680
    s_add_u32 m0, s73, 114688
    s_nop 0
    buffer_load_dwordx4 v253, s[40:43], s66 offen lds
    v_mfma_f32_32x32x16_bf16 v[160:175], v[228:231], v[20:23], v[160:175]
    ds_read_b64_tr_b16 v[220:221], v237 offset:2048
    ds_read_b64_tr_b16 v[222:223], v237 offset:3072
    s_add_u32 s66, s50, 335872
    s_add_u32 m0, s73, 115712
    s_nop 0
    buffer_load_dwordx4 v253, s[40:43], s66 offen lds
    s_add_u32 s67, s14, 12288
    buffer_load_dwordx4 v[52:55], v254, s[28:31], s67 offen offset:1024 sc1
    s_waitcnt lgkmcnt(4)
    s_waitcnt vmcnt(11)
    v_mfma_f32_32x32x16_bf16 v[144:159], v[208:211], v[24:27], v[144:159]
    v_add_u32 v236, 0x10000, v236
    v_add_u32 v237, 0x10000, v237
    ds_read_b64_tr_b16 v[224:225], v236 offset:32768
    ds_read_b64_tr_b16 v[226:227], v236 offset:33792
    v_mfma_f32_32x32x16_bf16 v[160:175], v[212:215], v[24:27], v[160:175]
    ds_read_b64_tr_b16 v[228:229], v237 offset:32768
    ds_read_b64_tr_b16 v[230:231], v237 offset:33792
    s_add_u32 s67, s14, 12288
    buffer_load_dwordx4 v[56:59], v254, s[28:31], s67 offen offset:2048 sc1
    s_waitcnt lgkmcnt(4)
    s_waitcnt vmcnt(11)
    v_mfma_f32_32x32x16_bf16 v[144:159], v[216:219], v[28:31], v[144:159]
    ds_read_b64_tr_b16 v[208:209], v236 offset:34816
    ds_read_b64_tr_b16 v[210:211], v236 offset:35840
    v_mfma_f32_32x32x16_bf16 v[160:175], v[220:223], v[28:31], v[160:175]
    ds_read_b64_tr_b16 v[212:213], v237 offset:34816
    ds_read_b64_tr_b16 v[214:215], v237 offset:35840
    s_add_u32 s67, s14, 12288
    buffer_load_dwordx4 v[60:63], v254, s[28:31], s67 offen offset:3072 sc1
    s_barrier
    s_waitcnt lgkmcnt(4)
    s_waitcnt vmcnt(11)
    v_mfma_f32_32x32x16_bf16 v[144:159], v[224:227], v[32:35], v[144:159]
    v_add_u32 v236, 0xffff0000, v236
    v_add_u32 v237, 0xffff0000, v237
    ds_read_b64_tr_b16 v[216:217], v236 offset:16384
    ds_read_b64_tr_b16 v[218:219], v236 offset:17408
    s_add_u32 s66, s50, 360448
    s_add_u32 m0, s73, 0
    s_nop 0
    buffer_load_dwordx4 v253, s[40:43], s66 offen lds
    v_mfma_f32_32x32x16_bf16 v[160:175], v[228:231], v[32:35], v[160:175]
    ds_read_b64_tr_b16 v[220:221], v237 offset:16384
    ds_read_b64_tr_b16 v[222:223], v237 offset:17408
    s_add_u32 s66, s50, 368640
    s_add_u32 m0, s73, 1024
    s_nop 0
    buffer_load_dwordx4 v253, s[40:43], s66 offen lds
    s_add_u32 s67, s14, 16384
    buffer_load_dwordx4 v[64:67], v254, s[28:31], s67 offen offset:0 sc1
    s_waitcnt lgkmcnt(4)
    s_waitcnt vmcnt(13)
    v_mfma_f32_32x32x16_bf16 v[144:159], v[208:211], v[36:39], v[144:159]
    ds_read_b64_tr_b16 v[224:225], v236 offset:18432
    ds_read_b64_tr_b16 v[226:227], v236 offset:19456
    s_add_u32 s66, s50, 393216
    s_add_u32 m0, s73, 131072
    s_nop 0
    buffer_load_dwordx4 v253, s[40:43], s66 offen lds
    v_mfma_f32_32x32x16_bf16 v[160:175], v[212:215], v[36:39], v[160:175]
    ds_read_b64_tr_b16 v[228:229], v237 offset:18432
    ds_read_b64_tr_b16 v[230:231], v237 offset:19456
    s_add_u32 s66, s50, 401408
    s_add_u32 m0, s73, 132096
    s_nop 0
    buffer_load_dwordx4 v253, s[40:43], s66 offen lds
    s_add_u32 s67, s14, 16384
    buffer_load_dwordx4 v[68:71], v254, s[28:31], s67 offen offset:1024 sc1
    s_waitcnt lgkmcnt(4)
    s_waitcnt vmcnt(15)
    v_mfma_f32_32x32x16_bf16 v[144:159], v[216:219], v[40:43], v[144:159]
    ds_read_b64_tr_b16 v[208:209], v236 offset:32768
    ds_read_b64_tr_b16 v[210:211], v236 offset:33792
    v_mfma_f32_32x32x16_bf16 v[160:175], v[220:223], v[40:43], v[160:175]
    ds_read_b64_tr_b16 v[212:213], v237 offset:32768
    ds_read_b64_tr_b16 v[214:215], v237 offset:33792
    s_add_u32 s67, s14, 16384
    buffer_load_dwordx4 v[72:75], v254, s[28:31], s67 offen offset:2048 sc1
    s_waitcnt lgkmcnt(4)
    s_waitcnt vmcnt(15)
    v_mfma_f32_32x32x16_bf16 v[144:159], v[224:227], v[44:47], v[144:159]
    ds_read_b64_tr_b16 v[216:217], v236 offset:34816
    ds_read_b64_tr_b16 v[218:219], v236 offset:35840
    v_mfma_f32_32x32x16_bf16 v[160:175], v[228:231], v[44:47], v[160:175]
    ds_read_b64_tr_b16 v[220:221], v237 offset:34816
    ds_read_b64_tr_b16 v[222:223], v237 offset:35840
    s_add_u32 s67, s14, 16384
    buffer_load_dwordx4 v[76:79], v254, s[28:31], s67 offen offset:3072 sc1
    s_barrier
    s_waitcnt lgkmcnt(4)
    s_waitcnt vmcnt(13)
    v_mfma_f32_32x32x16_bf16 v[144:159], v[208:211], v[48:51], v[144:159]
    ds_read_b64_tr_b16 v[224:225], v236 offset:49152
    ds_read_b64_tr_b16 v[226:227], v236 offset:50176
    s_add_u32 s66, s50, 425984
    s_add_u32 m0, s73, 98304
    s_nop 0
    buffer_load_dwordx4 v253, s[40:43], s66 offen lds
    v_mfma_f32_32x32x16_bf16 v[160:175], v[212:215], v[48:51], v[160:175]
    ds_read_b64_tr_b16 v[228:229], v237 offset:49152
    ds_read_b64_tr_b16 v[230:231], v237 offset:50176
    s_add_u32 s66, s50, 434176
    s_add_u32 m0, s73, 99328
    s_nop 0
    buffer_load_dwordx4 v253, s[40:43], s66 offen lds
    s_add_u32 s67, s14, 20480
    buffer_load_dwordx4 v[80:83], v254, s[28:31], s67 offen offset:0 sc1
    s_waitcnt lgkmcnt(4)
    s_waitcnt vmcnt(13)
    v_mfma_f32_32x32x16_bf16 v[144:159], v[216:219], v[52:55], v[144:159]
    ds_read_b64_tr_b16 v[208:209], v236 offset:51200
    ds_read_b64_tr_b16 v[210:211], v236 offset:52224
    v_mfma_f32_32x32x16_bf16 v[160:175], v[220:223], v[52:55], v[160:175]
    ds_read_b64_tr_b16 v[212:213], v237 offset:51200
    ds_read_b64_tr_b16 v[214:215], v237 offset:52224
    s_add_u32 s67, s14, 20480
    buffer_load_dwordx4 v[84:87], v254, s[28:31], s67 offen offset:1024 sc1
    s_waitcnt lgkmcnt(4)
    s_waitcnt vmcnt(13)
    v_mfma_f32_32x32x16_bf16 v[144:159], v[224:227], v[56:59], v[144:159]
    v_add_u32 v236, 0x10000, v236
    v_add_u32 v237, 0x10000, v237
    ds_read_b64_tr_b16 v[216:217], v236 offset:0
    ds_read_b64_tr_b16 v[218:219], v236 offset:1024
    v_mfma_f32_32x32x16_bf16 v[160:175], v[228:231], v[56:59], v[160:175]
    ds_read_b64_tr_b16 v[220:221], v237 offset:0
    ds_read_b64_tr_b16 v[222:223], v237 offset:1024
    s_add_u32 s67, s14, 20480
    buffer_load_dwordx4 v[88:91], v254, s[28:31], s67 offen offset:2048 sc1
    s_lshr_b32 s68, s74, 1
    s_add_u32 s66, s68, 56
    s_lshl_b32 s66, s66, 7
    v_and_b32 v239, 15, v255
    v_lshlrev_b32 v239, 2, v239
    v_add_u32 v239, s66, v239
    buffer_load_dword v248, v239, s[36:39], 0 offen sc1
    s_waitcnt lgkmcnt(4)
    s_waitcnt vmcnt(14)
    v_mfma_f32_32x32x16_bf16 v[144:159], v[208:211], v[60:63], v[144:159]
    ds_read_b64_tr_b16 v[224:225], v236 offset:2048
    ds_read_b64_tr_b16 v[226:227], v236 offset:3072
    v_mfma_f32_32x32x16_bf16 v[160:175], v[212:215], v[60:63], v[160:175]
    ds_read_b64_tr_b16 v[228:229], v237 offset:2048
    ds_read_b64_tr_b16 v[230:231], v237 offset:3072
    s_add_u32 s67, s14, 20480
    buffer_load_dwordx4 v[92:95], v254, s[28:31], s67 offen offset:3072 sc1
    s_barrier
    s_waitcnt lgkmcnt(4)
    s_waitcnt vmcnt(12)
    v_mfma_f32_32x32x16_bf16 v[144:159], v[216:219], v[64:67], v[144:159]
    ds_read_b64_tr_b16 v[208:209], v236 offset:16384
    ds_read_b64_tr_b16 v[210:211], v236 offset:17408
    v_mfma_f32_32x32x16_bf16 v[160:175], v[220:223], v[64:67], v[160:175]
    ds_read_b64_tr_b16 v[212:213], v237 offset:16384
    ds_read_b64_tr_b16 v[214:215], v237 offset:17408
    s_add_u32 s67, s14, 24576
    buffer_load_dwordx4 v[96:99], v254, s[28:31], s67 offen offset:0 sc1
    s_waitcnt lgkmcnt(4)
    s_waitcnt vmcnt(10)
    v_mfma_f32_32x32x16_bf16 v[144:159], v[224:227], v[68:71], v[144:159]
    ds_read_b64_tr_b16 v[216:217], v236 offset:18432
    ds_read_b64_tr_b16 v[218:219], v236 offset:19456
    v_mfma_f32_32x32x16_bf16 v[160:175], v[228:231], v[68:71], v[160:175]
    ds_read_b64_tr_b16 v[220:221], v237 offset:18432
    ds_read_b64_tr_b16 v[222:223], v237 offset:19456
    s_add_u32 s67, s14, 24576
    buffer_load_dwordx4 v[100:103], v254, s[28:31], s67 offen offset:1024 sc1
    s_waitcnt lgkmcnt(4)
    s_waitcnt vmcnt(10)
    v_mfma_f32_32x32x16_bf16 v[144:159], v[208:211], v[72:75], v[144:159]
    ds_read_b64_tr_b16 v[224:225], v236 offset:49152
    ds_read_b64_tr_b16 v[226:227], v236 offset:50176
    v_mfma_f32_32x32x16_bf16 v[160:175], v[212:215], v[72:75], v[160:175]
    ds_read_b64_tr_b16 v[228:229], v237 offset:49152
    ds_read_b64_tr_b16 v[230:231], v237 offset:50176
    s_add_u32 s67, s14, 24576
    buffer_load_dwordx4 v[104:107], v254, s[28:31], s67 offen offset:2048 sc1
    s_lshr_b32 s68, s74, 1
    s_waitcnt vmcnt(4)
    v_cmp_ne_u32 vcc, 0, v248
    s_nop 3
    s_and_b32 s66, vcc_lo, 0xff
    s_cmp_eq_u32 s66, 0xff
    s_cbranch_scc1 L_pc28
    s_add_u32 s66, s68, 56
    s_lshl_b32 s66, s66, 7
    v_and_b32 v239, 15, v255
    v_lshlrev_b32 v239, 2, v239
    v_add_u32 v239, s66, v239
    s_mov_b32 s78, 0x40000
L_spin29:
    buffer_load_dword v252, v239, s[36:39], 0 offen sc1
    s_waitcnt vmcnt(0)
    v_cmp_ne_u32 vcc, 0, v252
    s_nop 3
    s_and_b32 s66, vcc_lo, 0xff
    s_cmp_eq_u32 s66, 0xff
    s_cbranch_scc1 L_spun29
    s_sleep 8
    s_sub_u32 s78, s78, 1
    s_cbranch_scc0 L_spin29
L_spun29:
L_pc28:
    s_waitcnt lgkmcnt(4)
    v_mfma_f32_32x32x16_bf16 v[144:159], v[216:219], v[76:79], v[144:159]
    ds_read_b64_tr_b16 v[208:209], v236 offset:51200
    ds_read_b64_tr_b16 v[210:211], v236 offset:52224
    v_mfma_f32_32x32x16_bf16 v[160:175], v[220:223], v[76:79], v[160:175]
    ds_read_b64_tr_b16 v[212:213], v237 offset:51200
    ds_read_b64_tr_b16 v[214:215], v237 offset:52224
    s_add_u32 s67, s14, 24576
    buffer_load_dwordx4 v[108:111], v254, s[28:31], s67 offen offset:3072 sc1
    s_barrier
    s_waitcnt lgkmcnt(4)
    v_mfma_f32_32x32x16_bf16 v[144:159], v[224:227], v[80:83], v[144:159]
    v_add_u32 v236, 0xffff0000, v236
    v_add_u32 v237, 0xffff0000, v237
    ds_read_b64_tr_b16 v[216:217], v236 offset:0
    ds_read_b64_tr_b16 v[218:219], v236 offset:1024
    s_add_u32 s66, s51, 0
    s_add_u32 m0, s73, 65536
    s_nop 0
    buffer_load_dwordx4 v253, s[44:47], s66 offen lds
    v_mfma_f32_32x32x16_bf16 v[160:175], v[228:231], v[80:83], v[160:175]
    ds_read_b64_tr_b16 v[220:221], v237 offset:0
    ds_read_b64_tr_b16 v[222:223], v237 offset:1024
    s_add_u32 s66, s51, 8192
    s_add_u32 m0, s73, 66560
    s_nop 0
    buffer_load_dwordx4 v253, s[44:47], s66 offen lds
    s_add_u32 s67, s15, 28672
    buffer_load_dwordx4 v[112:115], v254, s[28:31], s67 offen offset:0 sc1
    s_waitcnt lgkmcnt(4)
    v_mfma_f32_32x32x16_bf16 v[144:159], v[208:211], v[84:87], v[144:159]
    ds_read_b64_tr_b16 v[224:225], v236 offset:2048
    ds_read_b64_tr_b16 v[226:227], v236 offset:3072
    s_add_u32 s66, s51, 32768
    s_add_u32 m0, s73, 81920
    s_nop 0
    buffer_load_dwordx4 v253, s[44:47], s66 offen lds
    v_mfma_f32_32x32x16_bf16 v[160:175], v[212:215], v[84:87], v[160:175]
    ds_read_b64_tr_b16 v[228:229], v237 offset:2048
    ds_read_b64_tr_b16 v[230:231], v237 offset:3072
    s_add_u32 s66, s51, 40960
    s_add_u32 m0, s73, 82944
    s_nop 0
    buffer_load_dwordx4 v253, s[44:47], s66 offen lds
    s_add_u32 s67, s15, 28672
    buffer_load_dwordx4 v[116:119], v254, s[28:31], s67 offen offset:1024 sc1
    s_waitcnt lgkmcnt(4)
    v_mfma_f32_32x32x16_bf16 v[144:159], v[216:219], v[88:91], v[144:159]
    v_add_u32 v236, 0x20000, v236
    v_add_u32 v237, 0x20000, v237
    ds_read_b64_tr_b16 v[208:209], v236 offset:0
    ds_read_b64_tr_b16 v[210:211], v236 offset:1024
    v_mfma_f32_32x32x16_bf16 v[160:175], v[220:223], v[88:91], v[160:175]
    ds_read_b64_tr_b16 v[212:213], v237 offset:0
    ds_read_b64_tr_b16 v[214:215], v237 offset:1024
    s_add_u32 s67, s15, 28672
    buffer_load_dwordx4 v[120:123], v254, s[28:31], s67 offen offset:2048 sc1
    s_waitcnt lgkmcnt(4)
    s_waitcnt vmcnt(11)
    v_mfma_f32_32x32x16_bf16 v[144:159], v[224:227], v[92:95], v[144:159]
    ds_read_b64_tr_b16 v[216:217], v236 offset:2048
    ds_read_b64_tr_b16 v[218:219], v236 offset:3072
    v_mfma_f32_32x32x16_bf16 v[160:175], v[228:231], v[92:95], v[160:175]
    ds_read_b64_tr_b16 v[220:221], v237 offset:2048
    ds_read_b64_tr_b16 v[222:223], v237 offset:3072
    s_add_u32 s67, s15, 28672
    buffer_load_dwordx4 v[124:127], v254, s[28:31], s67 offen offset:3072 sc1
    s_waitcnt vmcnt(6)
    s_barrier
    s_waitcnt lgkmcnt(4)
    v_mfma_f32_32x32x16_bf16 v[144:159], v[208:211], v[96:99], v[144:159]
    v_add_u32 v236, 0xffff0000, v236
    v_add_u32 v237, 0xffff0000, v237
    ds_read_b64_tr_b16 v[224:225], v236 offset:32768
    ds_read_b64_tr_b16 v[226:227], v236 offset:33792
    s_add_u32 s66, s51, 65536
    s_add_u32 m0, s73, 114688
    s_nop 0
    buffer_load_dwordx4 v253, s[44:47], s66 offen lds
    v_mfma_f32_32x32x16_bf16 v[160:175], v[212:215], v[96:99], v[160:175]
    ds_read_b64_tr_b16 v[228:229], v237 offset:32768
    ds_read_b64_tr_b16 v[230:231], v237 offset:33792
    s_add_u32 s66, s51, 73728
    s_add_u32 m0, s73, 115712
    s_nop 0
    buffer_load_dwordx4 v253, s[44:47], s66 offen lds
    s_add_u32 s67, s15, 32768
    buffer_load_dwordx4 v[128:131], v254, s[28:31], s67 offen offset:0 sc1
    s_waitcnt lgkmcnt(4)
    v_mfma_f32_32x32x16_bf16 v[144:159], v[216:219], v[100:103], v[144:159]
    ds_read_b64_tr_b16 v[208:209], v236 offset:34816
    ds_read_b64_tr_b16 v[210:211], v236 offset:35840
    v_mfma_f32_32x32x16_bf16 v[160:175], v[220:223], v[100:103], v[160:175]
    ds_read_b64_tr_b16 v[212:213], v237 offset:34816
    ds_read_b64_tr_b16 v[214:215], v237 offset:35840
    s_add_u32 s67, s15, 32768
    buffer_load_dwordx4 v[132:135], v254, s[28:31], s67 offen offset:1024 sc1
    s_waitcnt lgkmcnt(4)
    v_mfma_f32_32x32x16_bf16 v[144:159], v[224:227], v[104:107], v[144:159]
    ds_read_b64_tr_b16 v[216:217], v236 offset:0
    ds_read_b64_tr_b16 v[218:219], v236 offset:1024
    v_mfma_f32_32x32x16_bf16 v[160:175], v[228:231], v[104:107], v[160:175]
    ds_read_b64_tr_b16 v[220:221], v237 offset:0
    ds_read_b64_tr_b16 v[222:223], v237 offset:1024
    s_add_u32 s67, s15, 32768
    buffer_load_dwordx4 v[136:139], v254, s[28:31], s67 offen offset:2048 sc1
    s_waitcnt lgkmcnt(4)
    v_mfma_f32_32x32x16_bf16 v[144:159], v[208:211], v[108:111], v[144:159]
    ds_read_b64_tr_b16 v[224:225], v236 offset:2048
    ds_read_b64_tr_b16 v[226:227], v236 offset:3072
    v_mfma_f32_32x32x16_bf16 v[160:175], v[212:215], v[108:111], v[160:175]
    ds_read_b64_tr_b16 v[228:229], v237 offset:2048
    ds_read_b64_tr_b16 v[230:231], v237 offset:3072
    s_add_u32 s67, s15, 32768
    buffer_load_dwordx4 v[140:143], v254, s[28:31], s67 offen offset:3072 sc1
    s_waitcnt vmcnt(4)
    s_barrier
    s_waitcnt lgkmcnt(4)
    v_mfma_f32_32x32x16_bf16 v[176:191], v[216:219], v[112:115], 0
    ds_read_b64_tr_b16 v[208:209], v236 offset:16384
    ds_read_b64_tr_b16 v[210:211], v236 offset:17408
    s_add_u32 s66, s51, 98304
    s_add_u32 m0, s73, 98304
    s_nop 0
    buffer_load_dwordx4 v253, s[44:47], s66 offen lds
    v_and_b32 v1, 63, v255
    v_and_b32 v2, 31, v1
    v_mfma_f32_32x32x16_bf16 v[192:207], v[220:223], v[112:115], 0
    ds_read_b64_tr_b16 v[212:213], v237 offset:16384
    ds_read_b64_tr_b16 v[214:215], v237 offset:17408
    s_add_u32 s66, s51, 106496
    s_add_u32 m0, s73, 99328
    s_nop 0
    buffer_load_dwordx4 v253, s[44:47], s66 offen lds
    v_lshrrev_b32 v3, 5, v1
    v_and_b32 v4, 15, v2
    s_waitcnt lgkmcnt(4)
    v_mfma_f32_32x32x16_bf16 v[176:191], v[224:227], v[116:119], v[176:191]
    ds_read_b64_tr_b16 v[216:217], v236 offset:18432
    ds_read_b64_tr_b16 v[218:219], v236 offset:19456
    v_xor_b32 v4, v4, v3
    v_lshlrev_b32 v240, 8, v2
    v_mfma_f32_32x32x16_bf16 v[192:207], v[228:231], v[116:119], v[192:207]
    ds_read_b64_tr_b16 v[220:221], v237 offset:18432
    ds_read_b64_tr_b16 v[222:223], v237 offset:19456
    v_lshl_add_u32 v240, v4, 4, v240
    s_lshl_b32 s66, s49, 15
    s_lshl_b32 s68, s48, 13
    s_add_u32 s66, s66, s68
    v_add_u32 v240, s66, v240
    s_waitcnt lgkmcnt(4)
    v_mfma_f32_32x32x16_bf16 v[176:191], v[208:211], v[120:123], v[176:191]
    ds_read_b64_tr_b16 v[224:225], v236 offset:49152
    ds_read_b64_tr_b16 v[226:227], v236 offset:50176
    v_xor_b32 v5, 0, v240
    ds_write_b128 v5, v[144:147]
    v_xor_b32 v6, 32, v240
    ds_write_b128 v6, v[148:151]
    v_mfma_f32_32x32x16_bf16 v[192:207], v[212:215], v[120:123], v[192:207]
    ds_read_b64_tr_b16 v[228:229], v237 offset:49152
    ds_read_b64_tr_b16 v[230:231], v237 offset:50176
    v_xor_b32 v5, 64, v240
    ds_write_b128 v5, v[152:155]
    v_xor_b32 v6, 96, v240
    ds_write_b128 v6, v[156:159]
    s_waitcnt lgkmcnt(8)
    v_mfma_f32_32x32x16_bf16 v[176:191], v[216:219], v[124:127], v[176:191]
    ds_read_b64_tr_b16 v[208:209], v236 offset:51200
    ds_read_b64_tr_b16 v[210:211], v236 offset:52224
    v_xor_b32 v5, 128, v240
    ds_write_b128 v5, v[160:163]
    v_xor_b32 v6, 160, v240
    ds_write_b128 v6, v[164:167]
    v_mfma_f32_32x32x16_bf16 v[192:207], v[220:223], v[124:127], v[192:207]
    ds_read_b64_tr_b16 v[212:213], v237 offset:51200
    ds_read_b64_tr_b16 v[214:215], v237 offset:52224
    v_xor_b32 v5, 192, v240
    ds_write_b128 v5, v[168:171]
    v_xor_b32 v6, 224, v240
    ds_write_b128 v6, v[172:175]
    s_waitcnt lgkmcnt(0)
    s_waitcnt vmcnt(0)
    s_barrier
    v_mfma_f32_32x32x16_bf16 v[176:191], v[224:227], v[128:131], v[176:191]
    ds_read_b64_tr_b16 v[216:217], v236 offset:32768
    ds_read_b64_tr_b16 v[218:219], v236 offset:33792
    v_lshrrev_b32 v1, 3, v255
    v_and_b32 v2, 31, v1
    v_lshrrev_b32 v3, 5, v1
    v_lshlrev_b32 v3, 15, v3
    v_lshl_add_u32 v242, v2, 8, v3
    v_and_b32 v2, 15, v2
    v_and_b32 v4, 7, v255
    v_lshlrev_b32 v4, 1, v4
    v_xor_b32 v4, v4, v2
    v_lshl_add_u32 v242, v4, 4, v242
    v_xor_b32 v243, 16, v242
    ds_read_b128 v[64:67], v242 offset:0
    v_mfma_f32_32x32x16_bf16 v[192:207], v[228:231], v[128:131], v[192:207]
    ds_read_b64_tr_b16 v[220:221], v237 offset:32768
    ds_read_b64_tr_b16 v[222:223], v237 offset:33792
    ds_read_b128 v[68:71], v243 offset:0
    ds_read_b128 v[72:75], v242 offset:8192
    ds_read_b128 v[76:79], v243 offset:8192
    ds_read_b128 v[80:83], v242 offset:16384
    ds_read_b128 v[84:87], v243 offset:16384
    ds_read_b128 v[88:91], v242 offset:24576
    ds_read_b128 v[92:95], v243 offset:24576
    s_waitcnt lgkmcnt(5)
    v_add_f32 v8, v64, v72
    s_waitcnt lgkmcnt(1)
    v_add_f32 v16, v80, v88
    v_add_f32 v9, v65, v73
    v_add_f32 v17, v81, v89
    v_add_f32 v10, v66, v74
    v_mfma_f32_32x32x16_bf16 v[176:191], v[208:211], v[132:135], v[176:191]
    ds_read_b64_tr_b16 v[224:225], v236 offset:34816
    ds_read_b64_tr_b16 v[226:227], v236 offset:35840
    v_add_f32 v18, v82, v90
    v_add_f32 v11, v67, v75
    v_add_f32 v19, v83, v91
    v_add_f32 v12, v68, v76
    s_waitcnt lgkmcnt(2)
    v_add_f32 v20, v84, v92
    v_add_f32 v13, v69, v77
    v_add_f32 v21, v85, v93
    v_add_f32 v14, v70, v78
    v_add_f32 v22, v86, v94
    v_add_f32 v15, v71, v79
    v_add_f32 v23, v87, v95
    v_add_f32 v8, v8, v16
    v_mfma_f32_32x32x16_bf16 v[192:207], v[212:215], v[132:135], v[192:207]
    ds_read_b64_tr_b16 v[228:229], v237 offset:34816
    ds_read_b64_tr_b16 v[230:231], v237 offset:35840
    v_add_f32 v9, v9, v17
    v_add_f32 v10, v10, v18
    v_add_f32 v11, v11, v19
    v_add_f32 v12, v12, v20
    v_add_f32 v13, v13, v21
    v_add_f32 v14, v14, v22
    v_add_f32 v15, v15, v23
    v_mul_f32 v16, s70, v8
    v_mul_f32 v17, s70, v9
    v_mul_f32 v18, s70, v10
    v_mul_f32 v19, s70, v11
    v_mfma_f32_32x32x16_bf16 v[176:191], v[216:219], v[136:139], v[176:191]
    v_mul_f32 v20, s70, v12
    v_mul_f32 v21, s70, v13
    v_mul_f32 v22, s70, v14
    v_mul_f32 v23, s70, v15
    v_exp_f32 v16, -v16
    v_exp_f32 v17, -v17
    v_exp_f32 v18, -v18
    v_exp_f32 v19, -v19
    v_exp_f32 v20, -v20
    v_exp_f32 v21, -v21
    v_exp_f32 v22, -v22
    v_mfma_f32_32x32x16_bf16 v[192:207], v[220:223], v[136:139], v[192:207]
    v_exp_f32 v23, -v23
    v_add_f32 v16, 1.0, v16
    v_add_f32 v17, 1.0, v17
    v_add_f32 v18, 1.0, v18
    v_add_f32 v19, 1.0, v19
    v_add_f32 v20, 1.0, v20
    v_add_f32 v21, 1.0, v21
    v_add_f32 v22, 1.0, v22
    v_add_f32 v23, 1.0, v23
    v_rcp_f32 v16, v16
    v_rcp_f32 v17, v17
    s_waitcnt lgkmcnt(0)
    v_mfma_f32_32x32x16_bf16 v[176:191], v[224:227], v[140:143], v[176:191]
    v_rcp_f32 v18, v18
    v_rcp_f32 v19, v19
    v_rcp_f32 v20, v20
    v_rcp_f32 v21, v21
    v_rcp_f32 v22, v22
    v_rcp_f32 v23, v23
    v_mul_f32 v8, v8, v16
    v_mul_f32 v9, v9, v17
    v_mul_f32 v10, v10, v18
    v_mul_f32 v11, v11, v19
    v_mul_f32 v12, v12, v20
    v_mfma_f32_32x32x16_bf16 v[192:207], v[228:231], v[140:143], v[192:207]
    v_mul_f32 v13, v13, v21
    v_mul_f32 v14, v14, v22
    v_mul_f32 v15, v15, v23
    v_lshlrev_b32 v24, 16, v232
    v_and_b32 v25, 0xffff0000, v232
    v_lshlrev_b32 v26, 16, v233
    v_and_b32 v27, 0xffff0000, v233
    v_lshlrev_b32 v28, 16, v234
    v_and_b32 v29, 0xffff0000, v234
    v_lshlrev_b32 v30, 16, v235
    v_and_b32 v31, 0xffff0000, v235
    s_barrier
    v_xor_b32 v5, 0, v240
    ds_write_b128 v5, v[176:179]
    v_xor_b32 v6, 32, v240
    ds_write_b128 v6, v[180:183]
    v_xor_b32 v5, 64, v240
    ds_write_b128 v5, v[184:187]
    v_xor_b32 v6, 96, v240
    ds_write_b128 v6, v[188:191]
    v_xor_b32 v5, 128, v240
    ds_write_b128 v5, v[192:195]
    v_xor_b32 v6, 160, v240
    ds_write_b128 v6, v[196:199]
    v_xor_b32 v5, 192, v240
    ds_write_b128 v5, v[200:203]
    v_xor_b32 v6, 224, v240
    ds_write_b128 v6, v[204:207]
    s_waitcnt lgkmcnt(0)
    s_barrier
    ds_read_b128 v[64:67], v242 offset:0
    ds_read_b128 v[68:71], v243 offset:0
    ds_read_b128 v[72:75], v242 offset:8192
    ds_read_b128 v[76:79], v243 offset:8192
    ds_read_b128 v[80:83], v242 offset:16384
    ds_read_b128 v[84:87], v243 offset:16384
    ds_read_b128 v[88:91], v242 offset:24576
    ds_read_b128 v[92:95], v243 offset:24576
    s_waitcnt lgkmcnt(5)
    v_add_f32 v32, v64, v72
    s_waitcnt lgkmcnt(1)
    v_add_f32 v16, v80, v88
    v_add_f32 v33, v65, v73
    v_add_f32 v17, v81, v89
    v_add_f32 v34, v66, v74
    v_add_f32 v18, v82, v90
    v_add_f32 v35, v67, v75
    v_add_f32 v19, v83, v91
    v_add_f32 v36, v68, v76
    s_waitcnt lgkmcnt(0)
    v_add_f32 v20, v84, v92
    v_add_f32 v37, v69, v77
    v_add_f32 v21, v85, v93
    v_add_f32 v38, v70, v78
    v_add_f32 v22, v86, v94
    v_add_f32 v39, v71, v79
    v_add_f32 v23, v87, v95
    v_add_f32 v32, v32, v16
    v_add_f32 v33, v33, v17
    v_add_f32 v34, v34, v18
    v_add_f32 v35, v35, v19
    v_add_f32 v36, v36, v20
    v_add_f32 v37, v37, v21
    v_add_f32 v38, v38, v22
    v_add_f32 v39, v39, v23
    v_fma_f32 v32, v32, v8, v24
    v_fma_f32 v33, v33, v9, v25
    v_fma_f32 v34, v34, v10, v26
    v_fma_f32 v35, v35, v11, v27
    v_fma_f32 v36, v36, v12, v28
    v_fma_f32 v37, v37, v13, v29
    v_fma_f32 v38, v38, v14, v30
    v_fma_f32 v39, v39, v15, v31
    v_cvt_pk_bf16_f32 v56, v32, v33
    v_cvt_pk_bf16_f32 v57, v34, v35
    v_cvt_pk_bf16_f32 v58, v36, v37
    v_cvt_pk_bf16_f32 v59, v38, v39
    buffer_store_dwordx4 v[56:59], v238, s[20:23], 0 offen
    s_branch L_end
L_end:
    s_endpgm
.section .rodata,"a"
.p2align 6
.amdhsa_kernel recurrent_scan__linear_attn_block__glu_gated_geglu__prompt_kernel
  .amdhsa_next_free_vgpr 256
  .amdhsa_next_free_sgpr 102
  .amdhsa_accum_offset 256
  .amdhsa_group_segment_fixed_size 0
  .amdhsa_kernarg_size 80
  .amdhsa_user_sgpr_count 2
  .amdhsa_user_sgpr_kernarg_segment_ptr 1
  .amdhsa_system_sgpr_workgroup_id_x 1
  .amdhsa_float_denorm_mode_32 3
  .amdhsa_float_denorm_mode_16_64 3
.end_amdhsa_kernel
```
